```python
import torch

def _softmax(x, axis=-1):
    return torch.softmax(x, dim=axis)
def _gelu(x):
    return torch.nn.functional.gelu(x, approximate="tanh")
def _silu(x):
    return torch.nn.functional.silu(x)
def _sigmoid(x):
    return torch.sigmoid(x)
def _layernorm(x, axis=-1, eps=1e-5):
    m = x.mean(dim=axis, keepdim=True)
    v = x.var(dim=axis, keepdim=True, unbiased=False)
    return (x - m) / torch.sqrt(v + eps)
def _scatter_add(tgt, idx, src, axis=0):
    return tgt.clone().index_add_(axis, idx, src)
def _segment_sum(src, seg, n):
    out = torch.zeros((n,) + src.shape[1:], dtype=src.dtype)
    return out.index_add_(0, seg, src)
def _pad(x, pw):
    flat = tuple(v for pair in reversed(pw) for v in pair)
    return torch.nn.functional.pad(x, flat)

kernel_name = 'sequential_preLN__spectral_fnet__dense_activation_squared_relu__prompt'

def setup_inputs():

    _w = (lambda a: (lambda t: t.to(torch.bfloat16) if t.is_floating_point() else t)(torch.as_tensor(a)))
    def _A_setup():
        B, S, D = 1, 2048, 640
        ns = torch.arange(S)[:, None] * torch.arange(S)[None, :]
        nd = torch.arange(D)[:, None] * torch.arange(D)[None, :]
        Ws_re = torch.cos(-2.0 * torch.pi * ns / S).to(float)
        Ws_im = torch.sin(-2.0 * torch.pi * ns / S).to(float)
        Wd_re = torch.cos(-2.0 * torch.pi * nd / D).to(float)
        Wd_im = torch.sin(-2.0 * torch.pi * nd / D).to(float)
        return {
            "x": _w((lambda *s: torch.randn(*s, dtype=torch.bfloat16) * 0.05)(B, S, D)),
            "dft_seq_re": _w(Ws_re),
            "dft_seq_im": _w(Ws_im),
            "dft_hid_re": _w(Wd_re),
            "dft_hid_im": _w(Wd_im),
        }
    _A_in = _A_setup()

    def _B_setup():
        B, S, D, F = 1, 2048, 640, 1536
        return {
            "x": _w((lambda *s: torch.randn(*s, dtype=torch.bfloat16) * 0.05)(B, S, D)),
            "w1": _w((lambda *s: torch.randn(*s, dtype=torch.bfloat16) * 0.2)(D, F)),
            "b1": _w((lambda *s: torch.randn(*s, dtype=torch.bfloat16) * 0.2)(F)),
            "w2": _w((lambda *s: torch.randn(*s, dtype=torch.bfloat16) * 0.2)(F, D)),
            "b2": _w((lambda *s: torch.randn(*s, dtype=torch.bfloat16) * 0.2)(D)),
        }
    _B_in = _B_setup()

    return {
        "A_x": _A_in["x"],
        "A_dft_seq_re": _A_in["dft_seq_re"],
        "A_dft_seq_im": _A_in["dft_seq_im"],
        "A_dft_hid_re": _A_in["dft_hid_re"],
        "A_dft_hid_im": _A_in["dft_hid_im"],
        "B_x": _B_in["x"],
        "B_w1": _B_in["w1"],
        "B_b1": _B_in["b1"],
        "B_w2": _B_in["w2"],
        "B_b2": _B_in["b2"],
    }

def reference(A_x, A_dft_seq_re, A_dft_seq_im, A_dft_hid_re, A_dft_hid_im, B_x, B_w1, B_b1, B_w2, B_b2):
    def _A_ref(x, dft_seq_re, dft_seq_im, dft_hid_re, dft_hid_im):
        a = torch.einsum("bsd,ed->bse", x, dft_hid_re)
        b = torch.einsum("bsd,ed->bse", x, dft_hid_im)
        y = torch.einsum("ts,bse->bte", dft_seq_re, a) - torch.einsum("ts,bse->bte", dft_seq_im, b)
        return y

    def _B_ref(x, w1, b1, w2, b2):
        h = torch.einsum("bsd,df->bsf", x, w1) + b1
        zero = torch.zeros_like(h)
        r = torch.where(h > zero, h, zero)
        h = r * r
        out = torch.einsum("bsf,fd->bsd", h, w2) + b2
        return out

    x = A_x
    h = x + _A_ref(_layernorm(x, axis=-1), A_dft_seq_re, A_dft_seq_im, A_dft_hid_re, A_dft_hid_im)
    h2 = h + _B_ref(_layernorm(h, axis=-1), B_w1, B_b1, B_w2, B_b2)
    return h2
```

```asm
; @launch grid=(256,1,1) block=(256,1,1) lds=163840
.amdgcn_target "amdgcn-amd-amdhsa--gfx950"
.text
.globl sequential_preLN__spectral_fnet__dense_activation_squared_relu__prompt_kernel
.p2align 8
.type sequential_preLN__spectral_fnet__dense_activation_squared_relu__prompt_kernel,@function
sequential_preLN__spectral_fnet__dense_activation_squared_relu__prompt_kernel:
 s_cmp_ge_u32 s2, 256
 s_cbranch_scc1 FZ_END
 s_load_dwordx2 s[4:5], s[0:1], 0
 s_load_dwordx8 s[8:15], s[0:1], 48
 s_load_dwordx4 s[32:35], s[0:1], 80
 s_load_dwordx2 s[16:17], s[0:1], 96
 s_memrealtime s[60:61]
 s_getpc_b64 s[58:59]
 v_lshrrev_b32 v1, 6, v0
 v_and_b32 v0, 63, v0
 v_readfirstlane_b32 s3, v1
 s_lshr_b32 s38, s2, 3
 s_lshl_b32 s38, s38, 10
 v_lshl_add_u32 v30, v0, 7, s38
 s_cmp_lg_u32 s3, 3
 s_cbranch_scc1 FZ_NOCODE
 s_mov_b64 exec, 0xff
 global_load_dword v255, v30, s[58:59]
 s_mov_b64 exec, -1

FZ_NOCODE:
 s_and_b32 s36, s2, 7
 s_lshl_b32 s36, s36, 2
 s_bfe_u32 s37, s2, 0x20003
 s_add_u32 s36, s36, s37
 s_lshr_b32 s37, s2, 5
 v_and_b32 v1, 15, v0
 v_lshrrev_b32 v2, 4, v0
 v_mul_u32_u24 v31, 40960, v2
 v_lshl_add_u32 v30, v1, 7, v31
 s_lshl_b32 s41, s37, 2
 s_add_u32 s41, s41, s3
 s_lshl_b32 s41, s41, 6
 s_add_u32 s41, s41, s36
 s_mul_i32 s41, s41, 1280
 s_mov_b32 s6, 2621440
 s_mov_b32 s7, 0x20000
 s_mul_i32 s39, s3, 20480
 s_lshl_b32 s40, s3, 9
 s_add_u32 s40, s40, s36
 s_mul_i32 s40, s40, 1280
 v_lshlrev_b32 v3, 4, v0
 s_and_b32 s46, s3, 1
 s_lshr_b32 s47, s3, 1
 v_xor_b32 v28, v2, v1

 v_xor_b32 v29, 0, v28
 v_lshlrev_b32 v8, 4, v29
 v_lshrrev_b32 v29, 3, v29
 v_lshl_add_u32 v29, v29, 9, v31
 s_mov_b32 s42, 0
 v_add3_u32 v4, v29, v8, s42

 v_xor_b32 v29, 4, v28
 v_lshlrev_b32 v9, 4, v29
 v_lshrrev_b32 v29, 3, v29
 v_lshl_add_u32 v29, v29, 9, v31
 s_mov_b32 s42, 162816
 v_add3_u32 v5, v29, v9, s42

 v_xor_b32 v29, 8, v28
 v_lshlrev_b32 v10, 4, v29
 v_lshrrev_b32 v29, 3, v29
 v_lshl_add_u32 v29, v29, 9, v31
 s_mov_b32 s42, 325632
 v_add3_u32 v6, v29, v10, s42

 v_xor_b32 v29, 12, v28
 v_lshlrev_b32 v11, 4, v29
 v_lshrrev_b32 v29, 3, v29
 v_lshl_add_u32 v29, v29, 9, v31
 s_mov_b32 s42, 488448
 v_add3_u32 v7, v29, v11, s42

 v_lshrrev_b32 v205, 2, v0
 v_mul_u32_u24 v205, 3072, v205
 v_and_b32 v193, 3, v0
 v_lshl_add_u32 v205, v193, 7, v205
 s_lshl_b32 s42, s36, 2
 s_add_u32 s42, s42, s3
 s_mul_i32 s42, s42, 15360
 s_mul_i32 s44, s37, 384
 s_add_u32 s59, s42, s44

 s_mul_i32 s48, s47, 160
 s_lshl_b32 s49, s46, 2
 s_add_u32 s48, s48, s49
 v_lshl_add_u32 v21, v2, 3, s48
 v_cvt_f32_u32 v21, v21
 v_and_b32 v22, 1, v1
 v_cvt_f32_u32 v22, v22
 v_mul_f32 v22, 0x3e800000, v22
 v_bfe_u32 v23, v1, 1, 2
 v_lshrrev_b32 v25, 3, v1
 v_lshl_add_u32 v23, v23, 2, v25
 v_lshlrev_b32 v25, 31, v25
 v_xor_b32 v16, -1.0, v25
 s_lshl_b32 s48, s37, 5
 s_add_u32 s48, s48, 1
 v_add_u32 v26, s48, v23
 s_lshr_b32 s48, s37, 1
 s_lshl_b32 s48, s48, 4
 s_and_b32 s49, s37, 1
 s_lshl_b32 s49, s49, 1
 s_add_u32 s48, s48, s49
 s_add_u32 s48, s48, 257
 v_add_u32 v27, s48, v23
 v_cvt_f32_u32 v26, v26
 v_cvt_f32_u32 v27, v27
 s_mul_i32 s48, s47, 5120
 s_lshl_b32 s49, s46, 3
 s_add_u32 s48, s48, s49
 s_add_u32 s48, s48, 81920
 v_add_u32 v24, s48, v3
 v_mul_f32 v40, 0x3acccccd, v26
 v_fma_f32 v42, v40, v21, v22
 v_mul_f32 v41, 0x42000000, v40
 v_cos_f32 v41, v41
 v_cos_f32 v32, v42
 v_fmamk_f32 v33, v40, 0x3f800000, v42
 v_cos_f32 v33, v33
 v_fmamk_f32 v34, v40, 0x40000000, v42
 v_cos_f32 v34, v34
 v_fmamk_f32 v35, v40, 0x40400000, v42
 v_cos_f32 v35, v35
 v_fmamk_f32 v36, v40, 0x42000000, v42
 v_cos_f32 v36, v36
 v_fmamk_f32 v37, v40, 0x42040000, v42
 s_mov_b64 exec, 0x03ff03ff
 s_waitcnt lgkmcnt(0)
 buffer_load_dword v255, v30, s[4:7], s41 offen
 s_mov_b64 exec, -1
 s_add_u32 m0, s39, 0
 s_nop 0
 buffer_load_dwordx4 v4, s[4:7], s40 offen offset:0 lds
 buffer_load_dwordx4 v5, s[4:7], s40 offen offset:1024 lds
 buffer_load_dwordx4 v6, s[4:7], s40 offen offset:2048 lds
 buffer_load_dwordx4 v7, s[4:7], s40 offen offset:3072 lds
 v_cos_f32 v37, v37
 v_fmamk_f32 v38, v40, 0x42080000, v42
 v_cos_f32 v38, v38
 v_fmamk_f32 v39, v40, 0x420c0000, v42
 v_cos_f32 v39, v39
 v_add_f32 v40, v41, v41
 v_cvt_pk_bf16_f32 v44, v32, v33
 v_cvt_pk_bf16_f32 v45, v34, v35
 s_add_u32 m0, s39, 4096
 s_add_u32 s40, s40, 128
 buffer_load_dwordx4 v4, s[4:7], s40 offen offset:0 lds
 ds_write_b64 v24, v[44:45] offset:0
 v_cvt_pk_bf16_f32 v46, v36, v37
 v_cvt_pk_bf16_f32 v47, v38, v39
 ds_write_b64 v24, v[46:47] offset:1024
 v_add_f32 v56, 0x40000000, v26
 v_mul_f32 v56, 0x3acccccd, v56
 v_fma_f32 v58, v56, v21, v22
 v_mul_f32 v57, 0x42000000, v56
 buffer_load_dwordx4 v5, s[4:7], s40 offen offset:1024 lds
 v_cos_f32 v57, v57
 v_cos_f32 v48, v58
 v_fmamk_f32 v49, v56, 0x3f800000, v58
 v_cos_f32 v49, v49
 v_fmamk_f32 v50, v56, 0x40000000, v58
 v_cos_f32 v50, v50
 v_fmamk_f32 v51, v56, 0x40400000, v58
 v_cos_f32 v51, v51
 buffer_load_dwordx4 v6, s[4:7], s40 offen offset:2048 lds
 v_fmamk_f32 v52, v56, 0x42000000, v58
 v_cos_f32 v52, v52
 v_fmamk_f32 v53, v56, 0x42040000, v58
 v_cos_f32 v53, v53
 v_fmamk_f32 v54, v56, 0x42080000, v58
 v_cos_f32 v54, v54
 v_fmamk_f32 v55, v56, 0x420c0000, v58
 v_cos_f32 v55, v55
 buffer_load_dwordx4 v7, s[4:7], s40 offen offset:3072 lds
 v_add_f32 v56, v57, v57
 v_cvt_pk_bf16_f32 v60, v48, v49
 v_cvt_pk_bf16_f32 v61, v50, v51
 ds_write_b64 v24, v[60:61] offset:10240
 v_cvt_pk_bf16_f32 v62, v52, v53
 v_cvt_pk_bf16_f32 v63, v54, v55
 ds_write_b64 v24, v[62:63] offset:11264
 v_add_f32 v72, 0x41800000, v26
 s_mov_b64 s[24:25], s[10:11]
 s_mov_b32 s10, 1966080
 s_mov_b32 s11, 0x20000
 s_mov_b64 s[28:29], s[14:15]
 s_mov_b64 s[20:21], s[34:35]
 s_mov_b32 s22, 256
 s_mov_b32 s23, 0x20000
 s_or_b32 s41, s2, s3
 s_cmp_lg_u32 s41, 0
 s_cbranch_scc1 FZ_NOTAG
 s_or_b32 s60, s60, 1
 v_mov_b32 v252, s60
 v_mov_b32 v253, s61
 v_mov_b32 v30, 0
 s_mov_b64 exec, 1
 buffer_store_dwordx2 v[252:253], v30, s[20:23], 0 offen sc1
 s_mov_b64 exec, -1

FZ_NOTAG:
 s_mov_b64 exec, 0x77777
 buffer_load_dword v255, v205, s[8:11], s59 offen
 s_mov_b64 exec, -1
 v_mul_f32 v72, 0x3acccccd, v72
 v_fma_f32 v74, v72, v21, v22
 v_mul_f32 v73, 0x42000000, v72
 v_cos_f32 v73, v73
 v_cos_f32 v64, v74
 v_fmamk_f32 v65, v72, 0x3f800000, v74
 v_cos_f32 v65, v65
 v_fmamk_f32 v66, v72, 0x40000000, v74
 v_cos_f32 v66, v66
 v_fmamk_f32 v67, v72, 0x40400000, v74
 v_cos_f32 v67, v67
 v_fmamk_f32 v68, v72, 0x42000000, v74
 v_cos_f32 v68, v68
 v_fmamk_f32 v69, v72, 0x42040000, v74
 v_cos_f32 v69, v69
 v_fmamk_f32 v70, v72, 0x42080000, v74
 v_cos_f32 v70, v70
 v_fmamk_f32 v71, v72, 0x420c0000, v74
 v_cos_f32 v71, v71
 v_add_f32 v72, v73, v73
 v_cvt_pk_bf16_f32 v76, v64, v65
 v_cvt_pk_bf16_f32 v77, v66, v67
 ds_write_b64 v24, v[76:77] offset:20480
 v_cvt_pk_bf16_f32 v78, v68, v69
 v_cvt_pk_bf16_f32 v79, v70, v71
 ds_write_b64 v24, v[78:79] offset:21504
 v_add_f32 v88, 0x41900000, v26
 v_mul_f32 v88, 0x3acccccd, v88
 v_fma_f32 v90, v88, v21, v22
 v_mul_f32 v89, 0x42000000, v88
 v_cos_f32 v89, v89
 v_cos_f32 v80, v90
 v_fmamk_f32 v81, v88, 0x3f800000, v90
 v_cos_f32 v81, v81
 v_fmamk_f32 v82, v88, 0x40000000, v90
 v_cos_f32 v82, v82
 v_fmamk_f32 v83, v88, 0x40400000, v90
 v_cos_f32 v83, v83
 v_fmamk_f32 v84, v88, 0x42000000, v90
 v_cos_f32 v84, v84
 v_fmamk_f32 v85, v88, 0x42040000, v90
 v_cos_f32 v85, v85
 v_fmamk_f32 v86, v88, 0x42080000, v90
 v_cos_f32 v86, v86
 v_fmamk_f32 v87, v88, 0x420c0000, v90
 v_cos_f32 v87, v87
 v_add_f32 v88, v89, v89
 v_cvt_pk_bf16_f32 v92, v80, v81
 v_cvt_pk_bf16_f32 v93, v82, v83
 ds_write_b64 v24, v[92:93] offset:30720
 v_cvt_pk_bf16_f32 v94, v84, v85
 v_cvt_pk_bf16_f32 v95, v86, v87
 ds_write_b64 v24, v[94:95] offset:31744
 v_mul_f32 v104, 0x3acccccd, v27
 v_fma_f32 v106, v104, v21, v22
 v_mul_f32 v105, 0x42000000, v104
 v_cos_f32 v105, v105
 v_cos_f32 v96, v106
 v_fmamk_f32 v97, v104, 0x3f800000, v106
 v_cos_f32 v97, v97
 v_fmamk_f32 v98, v104, 0x40000000, v106
 v_cos_f32 v98, v98
 v_fmamk_f32 v99, v104, 0x40400000, v106
 v_cos_f32 v99, v99
 v_fmamk_f32 v100, v104, 0x42000000, v106
 v_cos_f32 v100, v100
 v_fmamk_f32 v101, v104, 0x42040000, v106
 v_cos_f32 v101, v101
 v_fmamk_f32 v102, v104, 0x42080000, v106
 v_cos_f32 v102, v102
 v_fmamk_f32 v103, v104, 0x420c0000, v106
 v_cos_f32 v103, v103
 v_add_f32 v104, v105, v105
 v_cvt_pk_bf16_f32 v108, v96, v97
 v_cvt_pk_bf16_f32 v109, v98, v99
 ds_write_b64 v24, v[108:109] offset:40960
 v_cvt_pk_bf16_f32 v110, v100, v101
 v_cvt_pk_bf16_f32 v111, v102, v103
 ds_write_b64 v24, v[110:111] offset:41984
 v_pk_fma_f32 v[32:33], v[40:41], v[36:37], v[32:33] op_sel_hi:[0,1,1] neg_lo:[0,0,1] neg_hi:[0,0,1]
 v_pk_fma_f32 v[34:35], v[40:41], v[38:39], v[34:35] op_sel_hi:[0,1,1] neg_lo:[0,0,1] neg_hi:[0,0,1]
 v_cvt_pk_bf16_f32 v44, v32, v33
 v_cvt_pk_bf16_f32 v45, v34, v35
 ds_write_b64 v24, v[44:45] offset:2048
 v_pk_fma_f32 v[48:49], v[56:57], v[52:53], v[48:49] op_sel_hi:[0,1,1] neg_lo:[0,0,1] neg_hi:[0,0,1]
 v_pk_fma_f32 v[50:51], v[56:57], v[54:55], v[50:51] op_sel_hi:[0,1,1] neg_lo:[0,0,1] neg_hi:[0,0,1]
 v_cvt_pk_bf16_f32 v60, v48, v49
 v_cvt_pk_bf16_f32 v61, v50, v51
 ds_write_b64 v24, v[60:61] offset:12288
 v_pk_fma_f32 v[64:65], v[72:73], v[68:69], v[64:65] op_sel_hi:[0,1,1] neg_lo:[0,0,1] neg_hi:[0,0,1]
 v_pk_fma_f32 v[66:67], v[72:73], v[70:71], v[66:67] op_sel_hi:[0,1,1] neg_lo:[0,0,1] neg_hi:[0,0,1]
 v_cvt_pk_bf16_f32 v76, v64, v65
 v_cvt_pk_bf16_f32 v77, v66, v67
 ds_write_b64 v24, v[76:77] offset:22528
 v_pk_fma_f32 v[80:81], v[88:89], v[84:85], v[80:81] op_sel_hi:[0,1,1] neg_lo:[0,0,1] neg_hi:[0,0,1]
 v_pk_fma_f32 v[82:83], v[88:89], v[86:87], v[82:83] op_sel_hi:[0,1,1] neg_lo:[0,0,1] neg_hi:[0,0,1]
 v_cvt_pk_bf16_f32 v92, v80, v81
 v_cvt_pk_bf16_f32 v93, v82, v83
 ds_write_b64 v24, v[92:93] offset:32768
 v_pk_fma_f32 v[96:97], v[104:105], v[100:101], v[96:97] op_sel_hi:[0,1,1] neg_lo:[0,0,1] neg_hi:[0,0,1]
 v_pk_fma_f32 v[98:99], v[104:105], v[102:103], v[98:99] op_sel_hi:[0,1,1] neg_lo:[0,0,1] neg_hi:[0,0,1]
 v_cvt_pk_bf16_f32 v108, v96, v97
 v_cvt_pk_bf16_f32 v109, v98, v99
 ds_write_b64 v24, v[108:109] offset:43008
 v_pk_fma_f32 v[36:37], v[40:41], v[32:33], v[36:37] op_sel_hi:[0,1,1] neg_lo:[0,0,1] neg_hi:[0,0,1]
 v_pk_fma_f32 v[38:39], v[40:41], v[34:35], v[38:39] op_sel_hi:[0,1,1] neg_lo:[0,0,1] neg_hi:[0,0,1]
 v_cvt_pk_bf16_f32 v46, v36, v37
 v_cvt_pk_bf16_f32 v47, v38, v39
 ds_write_b64 v24, v[46:47] offset:3072
 v_pk_fma_f32 v[52:53], v[56:57], v[48:49], v[52:53] op_sel_hi:[0,1,1] neg_lo:[0,0,1] neg_hi:[0,0,1]
 v_pk_fma_f32 v[54:55], v[56:57], v[50:51], v[54:55] op_sel_hi:[0,1,1] neg_lo:[0,0,1] neg_hi:[0,0,1]
 v_cvt_pk_bf16_f32 v62, v52, v53
 v_cvt_pk_bf16_f32 v63, v54, v55
 ds_write_b64 v24, v[62:63] offset:13312
 v_pk_fma_f32 v[68:69], v[72:73], v[64:65], v[68:69] op_sel_hi:[0,1,1] neg_lo:[0,0,1] neg_hi:[0,0,1]
 v_pk_fma_f32 v[70:71], v[72:73], v[66:67], v[70:71] op_sel_hi:[0,1,1] neg_lo:[0,0,1] neg_hi:[0,0,1]
 v_cvt_pk_bf16_f32 v78, v68, v69
 v_cvt_pk_bf16_f32 v79, v70, v71
 ds_write_b64 v24, v[78:79] offset:23552
 v_pk_fma_f32 v[84:85], v[88:89], v[80:81], v[84:85] op_sel_hi:[0,1,1] neg_lo:[0,0,1] neg_hi:[0,0,1]
 v_pk_fma_f32 v[86:87], v[88:89], v[82:83], v[86:87] op_sel_hi:[0,1,1] neg_lo:[0,0,1] neg_hi:[0,0,1]
 v_cvt_pk_bf16_f32 v94, v84, v85
 v_cvt_pk_bf16_f32 v95, v86, v87
 ds_write_b64 v24, v[94:95] offset:33792
 v_pk_fma_f32 v[100:101], v[104:105], v[96:97], v[100:101] op_sel_hi:[0,1,1] neg_lo:[0,0,1] neg_hi:[0,0,1]
 v_pk_fma_f32 v[102:103], v[104:105], v[98:99], v[102:103] op_sel_hi:[0,1,1] neg_lo:[0,0,1] neg_hi:[0,0,1]
 v_cvt_pk_bf16_f32 v110, v100, v101
 v_cvt_pk_bf16_f32 v111, v102, v103
 ds_write_b64 v24, v[110:111] offset:44032
 v_pk_fma_f32 v[32:33], v[40:41], v[36:37], v[32:33] op_sel_hi:[0,1,1] neg_lo:[0,0,1] neg_hi:[0,0,1]
 v_pk_fma_f32 v[34:35], v[40:41], v[38:39], v[34:35] op_sel_hi:[0,1,1] neg_lo:[0,0,1] neg_hi:[0,0,1]
 v_cvt_pk_bf16_f32 v44, v32, v33
 v_cvt_pk_bf16_f32 v45, v34, v35
 ds_write_b64 v24, v[44:45] offset:4096
 v_pk_fma_f32 v[48:49], v[56:57], v[52:53], v[48:49] op_sel_hi:[0,1,1] neg_lo:[0,0,1] neg_hi:[0,0,1]
 v_pk_fma_f32 v[50:51], v[56:57], v[54:55], v[50:51] op_sel_hi:[0,1,1] neg_lo:[0,0,1] neg_hi:[0,0,1]
 v_cvt_pk_bf16_f32 v60, v48, v49
 v_cvt_pk_bf16_f32 v61, v50, v51
 ds_write_b64 v24, v[60:61] offset:14336
 v_pk_fma_f32 v[64:65], v[72:73], v[68:69], v[64:65] op_sel_hi:[0,1,1] neg_lo:[0,0,1] neg_hi:[0,0,1]
 v_pk_fma_f32 v[66:67], v[72:73], v[70:71], v[66:67] op_sel_hi:[0,1,1] neg_lo:[0,0,1] neg_hi:[0,0,1]
 v_cvt_pk_bf16_f32 v76, v64, v65
 v_cvt_pk_bf16_f32 v77, v66, v67
 ds_write_b64 v24, v[76:77] offset:24576
 v_pk_fma_f32 v[80:81], v[88:89], v[84:85], v[80:81] op_sel_hi:[0,1,1] neg_lo:[0,0,1] neg_hi:[0,0,1]
 v_pk_fma_f32 v[82:83], v[88:89], v[86:87], v[82:83] op_sel_hi:[0,1,1] neg_lo:[0,0,1] neg_hi:[0,0,1]
 v_cvt_pk_bf16_f32 v92, v80, v81
 v_cvt_pk_bf16_f32 v93, v82, v83
 ds_write_b64 v24, v[92:93] offset:34816
 v_pk_fma_f32 v[96:97], v[104:105], v[100:101], v[96:97] op_sel_hi:[0,1,1] neg_lo:[0,0,1] neg_hi:[0,0,1]
 v_pk_fma_f32 v[98:99], v[104:105], v[102:103], v[98:99] op_sel_hi:[0,1,1] neg_lo:[0,0,1] neg_hi:[0,0,1]
 v_cvt_pk_bf16_f32 v108, v96, v97
 v_cvt_pk_bf16_f32 v109, v98, v99
 ds_write_b64 v24, v[108:109] offset:45056
 v_lshl_add_u32 v25, v1, 8, s39
 v_add_u32 v12, v8, v25
 v_add_u32 v13, v9, v25
 v_add_u32 v14, v10, v25
 v_add_u32 v15, v11, v25
 v_mov_b32 v248, 0x3f803f80
 v_mov_b32 v249, 0x3f803f80
 v_mov_b32 v250, 0x3f803f80
 v_mov_b32 v251, 0x3f803f80
 v_add_u32 v21, 81920, v3
 s_waitcnt lgkmcnt(0)
 s_barrier
 ds_read_b128 v[32:35], v21 offset:0
 ds_read_b128 v[36:39], v21 offset:10240
 ds_read_b128 v[40:43], v21 offset:20480
 ds_read_b128 v[44:47], v21 offset:30720
 ds_read_b128 v[48:51], v21 offset:40960
 ds_read_b128 v[52:55], v21 offset:1024
 ds_read_b128 v[56:59], v21 offset:11264
 ds_read_b128 v[60:63], v21 offset:21504
 ds_read_b128 v[64:67], v21 offset:31744
 ds_read_b128 v[68:71], v21 offset:41984
 v_lshrrev_b32 v192, 3, v0
 v_bfe_u32 v193, v0, 4, 1
 v_and_b32 v204, 7, v0
 v_lshlrev_b32 v193, 2, v193
 v_xor_b32 v204, v204, v193
 v_lshlrev_b32 v204, 4, v204
 s_mov_b32 s48, 3072
 s_mov_b32 s49, -3072
 s_mov_b32 s63, 1790976
 s_cmp_eq_u32 s46, 0
 s_cselect_b32 s54, s48, s63
 s_cselect_b32 s55, s48, s49
 s_cselect_b32 s57, 0, 172032
 v_mul_i32_i24 v192, s55, v192
 v_add3_u32 v24, v192, v204, s57
 s_lshl_b32 s57, s55, 4
 s_sub_u32 s57, s57, 1024
 v_add_u32 v25, s57, v24
 s_lshl_b32 s57, s57, 1
 v_add_u32 v26, s57, v24
 v_add_u32 v27, s57, v25
 s_lshl_b32 s48, s47, 7
 s_add_u32 s56, s44, s48
 s_add_u32 s48, s54, s56
 s_lshl_b32 s62, s55, 3
 s_mul_i32 s63, s55, 56
 v_bfe_u32 v195, v0, 2, 2
 v_lshl_add_u32 v192, v2, 3, v195
 v_and_b32 v193, 3, v0
 v_lshlrev_b32 v193, 3, v193
 v_lshl_add_u32 v200, v192, 6, v193
 v_lshrrev_b32 v192, 5, v0
 v_lshl_add_u32 v192, v192, 3, v195
 v_and_b32 v193, 16, v0
 v_lshl_add_u32 v193, v192, 7, v193
 v_and_b32 v192, 1, v0
 v_lshl_add_u32 v193, v192, 5, v193
 v_and_b32 v192, 2, v0
 v_lshl_add_u32 v193, v192, 2, v193
 v_and_b32 v192, 8, v0
 v_lshl_add_u32 v193, v192, 3, v193
 s_lshl_b32 s41, s46, 6
 v_xor_b32 v192, s41, v193
 s_lshl_b32 s41, s47, 6
 v_xor_b32 v186, s41, v193
 s_xor_b32 s41, s3, 1
 s_mul_i32 s41, s41, 20480
 v_add_u32 v184, s39, v192
 s_waitcnt vmcnt(5)
 ds_read_b128 a[160:163], v12 offset:0
 ds_read_b128 a[164:167], v14 offset:0
 ds_read_b128 a[168:171], v13 offset:0
 ds_read_b128 a[172:175], v15 offset:0
 s_add_u32 m0, s39, 8192
 s_add_u32 s40, s40, 128
 buffer_load_dwordx4 v4, s[4:7], s40 offen offset:0 lds
 buffer_load_dwordx4 v5, s[4:7], s40 offen offset:1024 lds
 buffer_load_dwordx4 v6, s[4:7], s40 offen offset:2048 lds
 buffer_load_dwordx4 v7, s[4:7], s40 offen offset:3072 lds
 s_waitcnt lgkmcnt(2)
 v_mfma_f32_16x16x32_bf16 v[160:163], a[160:163], a[160:163], 0
 s_add_u32 m0, s39, 12288
 s_add_u32 s40, s40, 128
 buffer_load_dwordx4 v4, s[4:7], s40 offen offset:0 lds
 v_mfma_f32_16x16x32_bf16 v[156:159], a[160:163], v[248:251], 0
 ds_read_b128 v[72:75], v21 offset:2048
 ds_read_b128 v[76:79], v21 offset:12288
 ds_read_b128 v[80:83], v21 offset:22528
 ds_read_b128 v[84:87], v21 offset:32768
 ds_read_b128 v[88:91], v21 offset:43008
 v_mfma_f32_16x16x32_bf16 v[160:163], a[164:167], a[164:167], v[160:163]
 v_add_u32 v185, s41, v192
 v_mov_b32 v30, 0
 v_mfma_f32_16x16x32_bf16 v[156:159], a[164:167], v[248:251], v[156:159]
 buffer_load_dwordx4 v5, s[4:7], s40 offen offset:1024 lds
 v_mfma_f32_16x16x32_bf16 v[116:119], a[160:163], v[32:35], 0
 s_mov_b32 s14, 1966080
 s_mov_b32 s15, 0x20000
 v_mfma_f32_16x16x32_bf16 v[120:123], a[160:163], v[36:39], 0
 s_min_u32 s43, s2, 239
 s_mul_i32 s42, s43, 13108
 v_mfma_f32_16x16x32_bf16 v[124:127], a[160:163], v[40:43], 0
 buffer_load_dwordx4 v6, s[4:7], s40 offen offset:2048 lds
 v_mfma_f32_16x16x32_bf16 v[128:131], a[160:163], v[44:47], 0
 s_lshr_b32 s42, s42, 16
 s_mul_i32 s50, s42, 5
 v_mfma_f32_16x16x32_bf16 v[132:135], a[160:163], v[48:51], 0
 s_sub_u32 s43, s43, s50
 s_mul_i32 s50, s42, 40960
 v_mfma_f32_16x16x32_bf16 v[136:139], a[164:167], v[32:35], 0
 buffer_load_dwordx4 v7, s[4:7], s40 offen offset:3072 lds
 v_mfma_f32_16x16x32_bf16 v[140:143], a[164:167], v[36:39], 0
 s_lshl_b32 s51, s43, 8
 s_add_u32 s50, s50, s51
 v_mfma_f32_16x16x32_bf16 v[144:147], a[164:167], v[40:43], 0
 s_lshl_b32 s51, s3, 6
 s_add_u32 s50, s50, s51
 v_mfma_f32_16x16x32_bf16 v[148:151], a[164:167], v[44:47], 0
 s_waitcnt vmcnt(9)
 ds_read_b128 a[176:179], v12 offset:4096
 ds_read_b128 a[180:183], v14 offset:4096
 ds_read_b128 a[184:187], v13 offset:4096
 ds_read_b128 a[188:191], v15 offset:4096
 v_mfma_f32_16x16x32_bf16 v[152:155], a[164:167], v[48:51], 0
 s_add_u32 s51, s50, 10240
 v_and_b32 v193, 3, v0
 s_waitcnt lgkmcnt(9)
 v_mfma_f32_16x16x32_bf16 v[160:163], a[168:171], a[168:171], v[160:163]
 s_add_u32 m0, s39, 16384
 s_add_u32 s40, s40, 128
 buffer_load_dwordx4 v4, s[4:7], s40 offen offset:0 lds
 v_mfma_f32_16x16x32_bf16 v[156:159], a[168:171], v[248:251], v[156:159]
 ds_read_b128 v[32:35], v21 offset:3072
 ds_read_b128 v[36:39], v21 offset:13312
 ds_read_b128 v[40:43], v21 offset:23552
 ds_read_b128 v[44:47], v21 offset:33792
 ds_read_b128 v[48:51], v21 offset:44032
 v_mfma_f32_16x16x32_bf16 v[160:163], a[172:175], a[172:175], v[160:163]
 v_lshrrev_b32 v192, 5, v0
 v_lshlrev_b32 v194, 1, v192
 v_mfma_f32_16x16x32_bf16 v[156:159], a[172:175], v[248:251], v[156:159]
 buffer_load_dwordx4 v5, s[4:7], s40 offen offset:1024 lds
 v_mfma_f32_16x16x32_bf16 v[116:119], a[168:171], v[52:55], v[116:119]
 v_xor_b32 v193, v193, v194
 v_bfe_u32 v194, v0, 2, 3
 v_mfma_f32_16x16x32_bf16 v[120:123], a[168:171], v[56:59], v[120:123]
 v_lshl_add_u32 v194, v192, 4, v194
 v_mul_u32_u24 v194, 1280, v194
 v_mfma_f32_16x16x32_bf16 v[124:127], a[168:171], v[60:63], v[124:127]
 buffer_load_dwordx4 v6, s[4:7], s40 offen offset:2048 lds
 v_mfma_f32_16x16x32_bf16 v[128:131], a[168:171], v[64:67], v[128:131]
 v_lshl_add_u32 v194, v193, 4, v194
 buffer_load_dwordx4 v7, s[4:7], s40 offen offset:3072 lds
 v_mfma_f32_16x16x32_bf16 v[132:135], a[168:171], v[68:71], v[132:135]
 buffer_load_dwordx4 v[224:227], v194, s[12:15], s50 offen
 buffer_load_dwordx4 v[228:231], v194, s[12:15], s51 offen
 v_mfma_f32_16x16x32_bf16 v[136:139], a[172:175], v[52:55], v[136:139]
 s_mov_b64 exec, 1
 buffer_load_dwordx2 v[252:253], v30, s[20:23], 0 offen sc1
 s_mov_b64 exec, -1
 s_mul_i32 s38, s3, 7680
 v_mfma_f32_16x16x32_bf16 v[140:143], a[172:175], v[56:59], v[140:143]
 s_add_u32 s38, s38, 133120
 v_and_b32 v192, 16, v0
 v_mfma_f32_16x16x32_bf16 v[144:147], a[172:175], v[60:63], v[144:147]
 v_lshl_add_u32 v200, v192, 1, v200
 v_add_u32 v28, s38, v200
 v_mfma_f32_16x16x32_bf16 v[148:151], a[172:175], v[64:67], v[148:151]
 v_xor_b32 v29, 32, v28
 v_add_u32 v31, s38, v3
 v_mfma_f32_16x16x32_bf16 v[152:155], a[172:175], v[68:71], v[152:155]
 s_mov_b32 s18, 67108864
 s_mov_b32 s19, 0x20000
 s_waitcnt lgkmcnt(7)
 v_mfma_f32_16x16x32_bf16 v[160:163], a[176:179], a[176:179], v[160:163]
 s_mul_i32 s50, s42, 43
 s_lshr_b32 s50, s50, 8
 v_mfma_f32_16x16x32_bf16 v[156:159], a[176:179], v[248:251], v[156:159]
 ds_read_b128 v[52:55], v21 offset:4096
 ds_read_b128 v[56:59], v21 offset:14336
 ds_read_b128 v[60:63], v21 offset:24576
 ds_read_b128 v[64:67], v21 offset:34816
 ds_read_b128 v[68:71], v21 offset:45056
 v_mfma_f32_16x16x32_bf16 v[160:163], a[180:183], a[180:183], v[160:163]
 s_mul_i32 s51, s50, 6
 s_sub_u32 s51, s42, s51
 v_mfma_f32_16x16x32_bf16 v[156:159], a[180:183], v[248:251], v[156:159]
 s_lshr_b32 s42, s50, 1
 s_and_b32 s50, s50, 1
 v_mfma_f32_16x16x32_bf16 v[116:119], a[176:179], v[72:75], v[116:119]
 s_lshl_b32 s52, s50, 1
 s_add_u32 s52, s52, 4
 v_mfma_f32_16x16x32_bf16 v[120:123], a[176:179], v[76:79], v[120:123]
 s_lshl_b32 s53, s50, 2
 s_cmp_ge_u32 s51, 4
 s_cselect_b32 s52, s52, s53
 v_mfma_f32_16x16x32_bf16 v[124:127], a[176:179], v[80:83], v[124:127]
 s_waitcnt vmcnt(11)
 ds_read_b128 a[192:195], v12 offset:8192
 ds_read_b128 a[196:199], v14 offset:8192
 ds_read_b128 a[200:203], v13 offset:8192
 ds_read_b128 a[204:207], v15 offset:8192
 v_mfma_f32_16x16x32_bf16 v[128:131], a[176:179], v[84:87], v[128:131]
 s_add_u32 s52, s52, s51
 s_lshr_b32 s53, s42, 1
 v_mfma_f32_16x16x32_bf16 v[132:135], a[176:179], v[88:91], v[132:135]
 s_xor_b32 s52, s52, s53
 s_mul_i32 s42, s42, 12
 v_mfma_f32_16x16x32_bf16 v[136:139], a[180:183], v[72:75], v[136:139]
 s_add_u32 s42, s42, s52
 s_mul_i32 s42, s42, 5
 v_mfma_f32_16x16x32_bf16 v[140:143], a[180:183], v[76:79], v[140:143]
 s_lshl_b32 s50, s43, 3
 s_lshl_b32 s51, s3, 1
 v_mfma_f32_16x16x32_bf16 v[144:147], a[180:183], v[80:83], v[144:147]
 s_add_u32 s50, s50, s51
 s_add_u32 s51, s50, 1
 v_mfma_f32_16x16x32_bf16 v[148:151], a[180:183], v[84:87], v[148:151]
 s_mul_i32 s52, s50, 52
 s_lshr_b32 s52, s52, 8
 v_mfma_f32_16x16x32_bf16 v[152:155], a[180:183], v[88:91], v[152:155]
 s_mul_i32 s52, s52, 235
 s_add_u32 s50, s50, s52
 s_waitcnt lgkmcnt(9)
 v_mfma_f32_16x16x32_bf16 v[160:163], a[184:187], a[184:187], v[160:163]
 s_mul_i32 s52, s51, 52
 s_lshr_b32 s52, s52, 8
 v_mfma_f32_16x16x32_bf16 v[156:159], a[184:187], v[248:251], v[156:159]
 ds_read_b128 v[72:75], v21 offset:5120
 ds_read_b128 v[76:79], v21 offset:15360
 ds_read_b128 v[80:83], v21 offset:25600
 ds_read_b128 v[84:87], v21 offset:35840
 ds_read_b128 v[88:91], v21 offset:46080
 v_mfma_f32_16x16x32_bf16 v[160:163], a[188:191], a[188:191], v[160:163]
 s_mul_i32 s52, s52, 235
 s_add_u32 s51, s51, s52
 v_mfma_f32_16x16x32_bf16 v[156:159], a[188:191], v[248:251], v[156:159]
 s_add_u32 s42, s42, 3072
 s_add_u32 s50, s50, s42
 v_mfma_f32_16x16x32_bf16 v[116:119], a[184:187], v[32:35], v[116:119]
 s_add_u32 s51, s51, s42
 s_lshl_b32 s50, s50, 10
 v_mfma_f32_16x16x32_bf16 v[120:123], a[184:187], v[36:39], v[120:123]
 s_lshl_b32 s51, s51, 10
 s_lshl_b32 s41, s3, 3
 v_mfma_f32_16x16x32_bf16 v[124:127], a[184:187], v[40:43], v[124:127]
 s_waitcnt vmcnt(7)
 ds_read_b128 a[208:211], v12 offset:12288
 ds_read_b128 a[212:215], v14 offset:12288
 ds_read_b128 a[216:219], v13 offset:12288
 ds_read_b128 a[220:223], v15 offset:12288
 v_mfma_f32_16x16x32_bf16 v[128:131], a[184:187], v[44:47], v[128:131]
 v_lshrrev_b32 v192, 1, v1
 v_add_u32 v192, s41, v192
 v_mfma_f32_16x16x32_bf16 v[132:135], a[184:187], v[48:51], v[132:135]
 v_sub_u32 v193, 64, v192
 v_cmp_eq_u32 vcc, 0, v192
 v_mfma_f32_16x16x32_bf16 v[136:139], a[188:191], v[32:35], v[136:139]
 v_and_b32 v196, 1, v1
 v_lshlrev_b32 v195, 3, v2
 v_mfma_f32_16x16x32_bf16 v[140:143], a[188:191], v[36:39], v[140:143]
 v_cndmask_b32 v193, v193, 32, vcc
 v_cmp_eq_u32 vcc, 1, v196
 v_mfma_f32_16x16x32_bf16 v[144:147], a[188:191], v[40:43], v[144:147]
 v_cvt_f32_u32 v195, v195
 s_mov_b32 s41, 0x80008000
 v_mfma_f32_16x16x32_bf16 v[148:151], a[188:191], v[44:47], v[148:151]
 v_cndmask_b32 v192, v192, v193, vcc
 v_and_b32 v193, 1, v192
 v_mfma_f32_16x16x32_bf16 v[152:155], a[188:191], v[48:51], v[152:155]
 v_mul_lo_u32 v193, v193, s41
 v_cvt_f32_u32 v192, v192
 s_waitcnt lgkmcnt(11)
 v_mfma_f32_16x16x32_bf16 v[160:163], a[192:195], a[192:195], v[160:163]
 v_mul_f32 v192, 0x3c800000, v192
 v_mul_f32 v196, v192, v195
 v_mfma_f32_16x16x32_bf16 v[156:159], a[192:195], v[248:251], v[156:159]
 ds_read_b128 v[32:35], v21 offset:6144
 ds_read_b128 v[36:39], v21 offset:16384
 ds_read_b128 v[40:43], v21 offset:26624
 ds_read_b128 v[44:47], v21 offset:36864
 ds_read_b128 v[48:51], v21 offset:47104
 v_mfma_f32_16x16x32_bf16 v[160:163], a[196:199], a[196:199], v[160:163]
 v_cos_f32 v168, v196
 v_sin_f32 v176, v196
 v_mfma_f32_16x16x32_bf16 v[156:159], a[196:199], v[248:251], v[156:159]
 s_add_u32 m0, s39, 0
 s_nop 0
 buffer_load_dwordx4 v24, s[8:11], s48 offen offset:0 lds
 v_fmamk_f32 v177, v192, 0x3f800000, v196
 v_mfma_f32_16x16x32_bf16 v[116:119], a[192:195], v[52:55], v[116:119]
 v_cos_f32 v169, v177
 v_sin_f32 v177, v177
 v_mfma_f32_16x16x32_bf16 v[120:123], a[192:195], v[56:59], v[120:123]
 buffer_load_dwordx4 v25, s[8:11], s48 offen offset:1024 lds
 v_fmamk_f32 v178, v192, 0x40000000, v196
 v_mfma_f32_16x16x32_bf16 v[124:127], a[192:195], v[60:63], v[124:127]
 s_waitcnt vmcnt(5)
 ds_read_b128 a[224:227], v12 offset:16384
 ds_read_b128 a[228:231], v14 offset:16384
 ds_read_b128 a[232:235], v13 offset:16384
 ds_read_b128 a[236:239], v15 offset:16384
 v_mfma_f32_16x16x32_bf16 v[128:131], a[192:195], v[64:67], v[128:131]
 buffer_load_dwordx4 v26, s[8:11], s48 offen offset:2048 lds
 v_cos_f32 v170, v178
 v_mfma_f32_16x16x32_bf16 v[132:135], a[192:195], v[68:71], v[132:135]
 v_sin_f32 v178, v178
 v_fmamk_f32 v179, v192, 0x40400000, v196
 v_mfma_f32_16x16x32_bf16 v[136:139], a[196:199], v[52:55], v[136:139]
 buffer_load_dwordx4 v27, s[8:11], s48 offen offset:3072 lds
 v_cos_f32 v171, v179
 v_mfma_f32_16x16x32_bf16 v[140:143], a[196:199], v[56:59], v[140:143]
 v_sin_f32 v179, v179
 v_fmamk_f32 v180, v192, 0x40800000, v196
 v_mfma_f32_16x16x32_bf16 v[144:147], a[196:199], v[60:63], v[144:147]
 v_cos_f32 v172, v180
 v_sin_f32 v180, v180
 v_mfma_f32_16x16x32_bf16 v[148:151], a[196:199], v[64:67], v[148:151]
 v_fmamk_f32 v181, v192, 0x40a00000, v196
 v_cos_f32 v173, v181
 v_mfma_f32_16x16x32_bf16 v[152:155], a[196:199], v[68:71], v[152:155]
 v_sin_f32 v181, v181
 v_fmamk_f32 v182, v192, 0x40c00000, v196
 s_waitcnt lgkmcnt(13)
 v_mfma_f32_16x16x32_bf16 v[160:163], a[200:203], a[200:203], v[160:163]
 v_cos_f32 v174, v182
 v_sin_f32 v182, v182
 v_mfma_f32_16x16x32_bf16 v[156:159], a[200:203], v[248:251], v[156:159]
 ds_read_b128 v[52:55], v21 offset:7168
 ds_read_b128 v[56:59], v21 offset:17408
 ds_read_b128 v[60:63], v21 offset:27648
 ds_read_b128 v[64:67], v21 offset:37888
 ds_read_b128 v[68:71], v21 offset:48128
 v_mfma_f32_16x16x32_bf16 v[160:163], a[204:207], a[204:207], v[160:163]
 v_fmamk_f32 v183, v192, 0x40e00000, v196
 v_cos_f32 v175, v183
 v_mfma_f32_16x16x32_bf16 v[156:159], a[204:207], v[248:251], v[156:159]
 s_add_u32 m0, s39, 4096
 s_add_u32 s48, s48, s62
 buffer_load_dwordx4 v24, s[8:11], s48 offen offset:0 lds
 v_sin_f32 v183, v183
 v_mfma_f32_16x16x32_bf16 v[116:119], a[200:203], v[72:75], v[116:119]
 v_cvt_pk_bf16_f32 v232, v168, v169
 v_cvt_pk_bf16_f32 v240, v176, v177
 v_mfma_f32_16x16x32_bf16 v[120:123], a[200:203], v[76:79], v[120:123]
 buffer_load_dwordx4 v25, s[8:11], s48 offen offset:1024 lds
 v_cvt_pk_bf16_f32 v233, v170, v171
 v_mfma_f32_16x16x32_bf16 v[124:127], a[200:203], v[80:83], v[124:127]
 v_cvt_pk_bf16_f32 v241, v178, v179
 v_cvt_pk_bf16_f32 v234, v172, v173
 v_mfma_f32_16x16x32_bf16 v[128:131], a[200:203], v[84:87], v[128:131]
 buffer_load_dwordx4 v26, s[8:11], s48 offen offset:2048 lds
 v_cvt_pk_bf16_f32 v242, v180, v181
 v_mfma_f32_16x16x32_bf16 v[132:135], a[200:203], v[88:91], v[132:135]
 v_cvt_pk_bf16_f32 v235, v174, v175
 v_cvt_pk_bf16_f32 v243, v182, v183
 v_mfma_f32_16x16x32_bf16 v[136:139], a[204:207], v[72:75], v[136:139]
 buffer_load_dwordx4 v27, s[8:11], s48 offen offset:3072 lds
 v_xor_b32 v236, v193, v232
 v_mfma_f32_16x16x32_bf16 v[140:143], a[204:207], v[76:79], v[140:143]
 v_xor_b32 v244, v193, v240
 v_xor_b32 v237, v193, v233
 v_mfma_f32_16x16x32_bf16 v[144:147], a[204:207], v[80:83], v[144:147]
 v_xor_b32 v245, v193, v241
 v_xor_b32 v238, v193, v234
 v_mfma_f32_16x16x32_bf16 v[148:151], a[204:207], v[84:87], v[148:151]
 v_xor_b32 v246, v193, v242
 v_xor_b32 v239, v193, v235
 v_mfma_f32_16x16x32_bf16 v[152:155], a[204:207], v[88:91], v[152:155]
 v_xor_b32 v247, v193, v243
 v_mul_u32_u24 v192, 48, v1
 s_waitcnt lgkmcnt(9)
 v_mfma_f32_16x16x32_bf16 v[160:163], a[208:211], a[208:211], v[160:163]
 v_lshl_add_u32 v193, v2, 3, s38
 v_add_u32 v197, v192, v193
 v_mfma_f32_16x16x32_bf16 v[156:159], a[208:211], v[248:251], v[156:159]
 ds_read_b128 v[72:75], v21 offset:8192
 ds_read_b128 v[76:79], v21 offset:18432
 ds_read_b128 v[80:83], v21 offset:28672
 ds_read_b128 v[84:87], v21 offset:38912
 ds_read_b128 v[88:91], v21 offset:49152
 v_mfma_f32_16x16x32_bf16 v[160:163], a[212:215], a[212:215], v[160:163]
 v_and_b32 v198, 16, v0
 v_lshrrev_b32 v195, 5, v0
 v_mfma_f32_16x16x32_bf16 v[156:159], a[212:215], v[248:251], v[156:159]
 s_add_u32 m0, s39, 8192
 s_add_u32 s48, s48, s63
 buffer_load_dwordx4 v24, s[8:11], s48 offen offset:0 lds
 v_mul_u32_u24 v195, 7680, v195
 v_mfma_f32_16x16x32_bf16 v[116:119], a[208:211], v[32:35], v[116:119]
 v_add3_u32 v198, v198, v192, v195
 v_add_u32 v198, 133120, v198
 v_mfma_f32_16x16x32_bf16 v[120:123], a[208:211], v[36:39], v[120:123]
 buffer_load_dwordx4 v25, s[8:11], s48 offen offset:1024 lds
 v_mad_u32_u24 v199, v192, 3, v193
 v_mfma_f32_16x16x32_bf16 v[124:127], a[208:211], v[40:43], v[124:127]
 v_lshl_add_u32 v200, v1, 5, v193
 v_lshrrev_b32 v192, 3, v0
 v_mfma_f32_16x16x32_bf16 v[128:131], a[208:211], v[44:47], v[128:131]
 buffer_load_dwordx4 v26, s[8:11], s48 offen offset:2048 lds
 v_lshl_add_u32 v201, v192, 4, v31
 v_mfma_f32_16x16x32_bf16 v[132:135], a[208:211], v[48:51], v[132:135]
 v_and_b32 v193, 7, v0
 v_mul_u32_u24 v192, 40960, v192
 v_mfma_f32_16x16x32_bf16 v[136:139], a[212:215], v[32:35], v[136:139]
 buffer_load_dwordx4 v27, s[8:11], s48 offen offset:3072 lds
 v_lshl_add_u32 v202, v193, 4, v192
 v_mfma_f32_16x16x32_bf16 v[140:143], a[212:215], v[36:39], v[140:143]
 v_lshrrev_b32 v192, 1, v0
 v_and_b32 v193, 1, v0
 v_mfma_f32_16x16x32_bf16 v[144:147], a[212:215], v[40:43], v[144:147]
 v_mul_u32_u24 v192, 40960, v192
 v_lshl_add_u32 v203, v193, 4, v192
 v_mfma_f32_16x16x32_bf16 v[148:151], a[212:215], v[44:47], v[148:151]
 s_mul_i32 s42, s3, 655360
 s_mul_i32 s41, s36, 1280
 v_mfma_f32_16x16x32_bf16 v[152:155], a[212:215], v[48:51], v[152:155]
 s_add_u32 s42, s42, s41
 s_lshl_b32 s41, s37, 5
 s_waitcnt lgkmcnt(5)
 v_mfma_f32_16x16x32_bf16 v[160:163], a[216:219], a[216:219], v[160:163]
 s_add_u32 s43, s42, s41
 s_add_u32 s43, s43, 1024
 v_mfma_f32_16x16x32_bf16 v[156:159], a[216:219], v[248:251], v[156:159]
 ds_read_b128 v[32:35], v21 offset:9216
 ds_read_b128 v[36:39], v21 offset:19456
 ds_read_b128 v[40:43], v21 offset:29696
 ds_read_b128 v[44:47], v21 offset:39936
 ds_read_b128 v[48:51], v21 offset:50176
 v_mfma_f32_16x16x32_bf16 v[160:163], a[220:223], a[220:223], v[160:163]
 s_lshl_b32 s41, s37, 7
 s_add_u32 s42, s42, s41
 v_mfma_f32_16x16x32_bf16 v[156:159], a[220:223], v[248:251], v[156:159]
 s_add_u32 m0, s39, 12288
 s_add_u32 s48, s48, s62
 buffer_load_dwordx4 v24, s[8:11], s48 offen offset:0 lds
 s_add_u32 s41, s42, 327680
 v_mfma_f32_16x16x32_bf16 v[116:119], a[216:219], v[52:55], v[116:119]
 s_mov_b32 s52, 0x3acccccd
 s_mov_b32 s53, 0x3acccccd
 v_mfma_f32_16x16x32_bf16 v[120:123], a[216:219], v[56:59], v[120:123]
 buffer_load_dwordx4 v25, s[8:11], s48 offen offset:1024 lds
 s_mul_i32 s45, s46, -9
 v_mfma_f32_16x16x32_bf16 v[124:127], a[216:219], v[60:63], v[124:127]
 s_add_u32 s45, s45, 64
 s_mul_i32 s49, s55, 264
 v_mfma_f32_16x16x32_bf16 v[128:131], a[216:219], v[64:67], v[128:131]
 buffer_load_dwordx4 v26, s[8:11], s48 offen offset:2048 lds
 s_add_u32 s49, s49, s54
 v_mfma_f32_16x16x32_bf16 v[132:135], a[216:219], v[68:71], v[132:135]
 v_cmp_lt_u32 vcc, s45, v0
 s_add_u32 s49, s49, 3072
 v_mfma_f32_16x16x32_bf16 v[136:139], a[220:223], v[52:55], v[136:139]
 buffer_load_dwordx4 v27, s[8:11], s48 offen offset:3072 lds
 v_add_u32 v22, s49, v27
 v_mfma_f32_16x16x32_bf16 v[140:143], a[220:223], v[56:59], v[140:143]
 v_cndmask_b32 v22, v22, v204, vcc
 v_mfma_f32_16x16x32_bf16 v[144:147], a[220:223], v[60:63], v[144:147]
 v_mfma_f32_16x16x32_bf16 v[148:151], a[220:223], v[64:67], v[148:151]
 v_mfma_f32_16x16x32_bf16 v[152:155], a[220:223], v[68:71], v[152:155]
 s_waitcnt vmcnt(12)
 s_barrier
 s_waitcnt lgkmcnt(5)
 v_mfma_f32_16x16x32_bf16 v[160:163], a[224:227], a[224:227], v[160:163]
 v_mfma_f32_16x16x32_bf16 v[156:159], a[224:227], v[248:251], v[156:159]
 ds_read_b64_tr_b16 a[0:1], v184 offset:0
 v_mfma_f32_16x16x32_bf16 v[160:163], a[228:231], a[228:231], v[160:163]
 v_mfma_f32_16x16x32_bf16 v[156:159], a[228:231], v[248:251], v[156:159]
 ds_read_b64_tr_b16 a[2:3], v184 offset:512
 v_mfma_f32_16x16x32_bf16 v[116:119], a[224:227], v[72:75], v[116:119]
 ds_read_b64_tr_b16 a[4:5], v184 offset:2048
 v_mfma_f32_16x16x32_bf16 v[120:123], a[224:227], v[76:79], v[120:123]
 ds_read_b64_tr_b16 a[6:7], v184 offset:2560
 v_mfma_f32_16x16x32_bf16 v[124:127], a[224:227], v[80:83], v[124:127]
 ds_read_b64_tr_b16 a[8:9], v185 offset:0
 v_mfma_f32_16x16x32_bf16 v[128:131], a[224:227], v[84:87], v[128:131]
 ds_read_b64_tr_b16 a[10:11], v185 offset:512
 v_mfma_f32_16x16x32_bf16 v[132:135], a[224:227], v[88:91], v[132:135]
 ds_read_b64_tr_b16 a[12:13], v185 offset:2048
 v_mfma_f32_16x16x32_bf16 v[136:139], a[228:231], v[72:75], v[136:139]
 ds_read_b64_tr_b16 a[14:15], v185 offset:2560
 v_mfma_f32_16x16x32_bf16 v[140:143], a[228:231], v[76:79], v[140:143]
 s_add_u32 m0, s39, 16384
 s_add_u32 s48, s48, s63
 buffer_load_dwordx4 v24, s[8:11], s48 offen offset:0 lds
 v_mfma_f32_16x16x32_bf16 v[144:147], a[228:231], v[80:83], v[144:147]
 buffer_load_dwordx4 v25, s[8:11], s48 offen offset:1024 lds
 v_mfma_f32_16x16x32_bf16 v[148:151], a[228:231], v[84:87], v[148:151]
 buffer_load_dwordx4 v26, s[8:11], s48 offen offset:2048 lds
 v_mfma_f32_16x16x32_bf16 v[152:155], a[228:231], v[88:91], v[152:155]
 buffer_load_dwordx4 v27, s[8:11], s48 offen offset:3072 lds
 s_waitcnt vmcnt(12) lgkmcnt(0)
 s_barrier
 v_mfma_f32_16x16x32_bf16 v[160:163], a[232:235], a[232:235], v[160:163]
 ds_write_b128 v31, v[224:227] offset:3840
 v_mfma_f32_16x16x32_bf16 v[156:159], a[232:235], v[248:251], v[156:159]
 ds_write_b128 v31, v[228:231] offset:4864
 ds_read_b64_tr_b16 a[16:17], v184 offset:4096
 v_mfma_f32_16x16x32_bf16 v[160:163], a[236:239], a[236:239], v[160:163]
 ds_read_b64_tr_b16 v[216:217], v28 offset:3840
 v_mfma_f32_16x16x32_bf16 v[156:159], a[236:239], v[248:251], v[156:159]
 ds_read_b64_tr_b16 v[218:219], v28 offset:4096
 ds_read_b64_tr_b16 a[18:19], v184 offset:4608
 v_mfma_f32_16x16x32_bf16 v[116:119], a[232:235], v[32:35], v[116:119]
 ds_read_b64_tr_b16 v[220:221], v29 offset:3840
 ds_read_b64_tr_b16 a[20:21], v184 offset:6144
 v_mfma_f32_16x16x32_bf16 v[120:123], a[232:235], v[36:39], v[120:123]
 ds_read_b64_tr_b16 v[222:223], v29 offset:4096
 ds_read_b64_tr_b16 a[22:23], v184 offset:6656
 v_mfma_f32_16x16x32_bf16 v[124:127], a[232:235], v[40:43], v[124:127]
 ds_read_b64_tr_b16 a[24:25], v185 offset:4096
 v_mfma_f32_16x16x32_bf16 v[128:131], a[232:235], v[44:47], v[128:131]
 ds_read_b64_tr_b16 a[26:27], v185 offset:4608
 v_mfma_f32_16x16x32_bf16 v[132:135], a[232:235], v[48:51], v[132:135]
 ds_read_b64_tr_b16 a[28:29], v185 offset:6144
 v_mfma_f32_16x16x32_bf16 v[136:139], a[236:239], v[32:35], v[136:139]
 ds_read_b64_tr_b16 a[30:31], v185 offset:6656
 v_mfma_f32_16x16x32_bf16 v[140:143], a[236:239], v[36:39], v[140:143]
 s_waitcnt lgkmcnt(5)
 buffer_store_dwordx4 v[216:219], v3, s[16:19], s50 offen sc1
 v_mov_b32_dpp v164, v160 row_newbcast:0 row_mask:0x1 bank_mask:0xf
 v_mov_b32_dpp v165, v161 row_newbcast:1 row_mask:0x1 bank_mask:0xf
 v_mov_b32_dpp v166, v162 row_newbcast:2 row_mask:0x1 bank_mask:0xf
 v_mfma_f32_16x16x32_bf16 v[144:147], a[236:239], v[40:43], v[144:147]
 buffer_store_dwordx4 v[220:223], v3, s[16:19], s51 offen sc1
 v_mov_b32_dpp v167, v163 row_newbcast:3 row_mask:0x1 bank_mask:0xf
 v_mov_b32_dpp v164, v160 row_newbcast:4 row_mask:0x2 bank_mask:0xf
 v_mov_b32_dpp v165, v161 row_newbcast:5 row_mask:0x2 bank_mask:0xf
 v_mfma_f32_16x16x32_bf16 v[148:151], a[236:239], v[44:47], v[148:151]
 v_mov_b32_dpp v166, v162 row_newbcast:6 row_mask:0x2 bank_mask:0xf
 v_mov_b32_dpp v167, v163 row_newbcast:7 row_mask:0x2 bank_mask:0xf
 v_mov_b32_dpp v164, v160 row_newbcast:8 row_mask:0x4 bank_mask:0xf
 v_mfma_f32_16x16x32_bf16 v[152:155], a[236:239], v[48:51], v[152:155]
 v_mov_b32_dpp v165, v161 row_newbcast:9 row_mask:0x4 bank_mask:0xf
 v_mov_b32_dpp v166, v162 row_newbcast:10 row_mask:0x4 bank_mask:0xf
 v_mov_b32_dpp v167, v163 row_newbcast:11 row_mask:0x4 bank_mask:0xf
 v_mov_b32_dpp v164, v160 row_newbcast:12 row_mask:0x8 bank_mask:0xf
 v_mov_b32_dpp v165, v161 row_newbcast:13 row_mask:0x8 bank_mask:0xf
 v_mov_b32_dpp v166, v162 row_newbcast:14 row_mask:0x8 bank_mask:0xf
 v_mov_b32_dpp v167, v163 row_newbcast:15 row_mask:0x8 bank_mask:0xf
 s_add_u32 m0, s39, 0
 s_add_u32 s48, s48, s62
 buffer_load_dwordx4 v24, s[8:11], s48 offen offset:0 lds
 buffer_load_dwordx4 v25, s[8:11], s48 offen offset:1024 lds
 buffer_load_dwordx4 v26, s[8:11], s48 offen offset:2048 lds
 buffer_load_dwordx4 v27, s[8:11], s48 offen offset:3072 lds
 v_pk_mul_f32 v[156:157], s[52:53], v[156:157]
 v_pk_mul_f32 v[158:159], s[52:53], v[158:159]
 v_pk_mul_f32 v[164:165], s[52:53], v[164:165]
 v_pk_mul_f32 v[166:167], s[52:53], v[166:167]
 v_pk_fma_f32 v[164:165], v[156:157], v[156:157], v[164:165] neg_lo:[1,0,0] neg_hi:[1,0,0]
 v_pk_fma_f32 v[166:167], v[158:159], v[158:159], v[166:167] neg_lo:[1,0,0] neg_hi:[1,0,0]

 v_max_f32 v164, 0, v164
 v_max_f32 v165, 0, v165
 v_max_f32 v166, 0, v166
 v_max_f32 v167, 0, v167
 v_add_f32 v164, 0x3727c5ac, v164
 v_add_f32 v165, 0x3727c5ac, v165
 v_add_f32 v166, 0x3727c5ac, v166
 v_add_f32 v167, 0x3727c5ac, v167
 v_rsq_f32 v164, v164
 v_rsq_f32 v165, v165
 v_rsq_f32 v166, v166
 v_rsq_f32 v167, v167
 v_pk_fma_f32 v[116:117], v[16:17], v[136:137], v[116:117] op_sel_hi:[0,1,1]
 v_pk_fma_f32 v[118:119], v[16:17], v[138:139], v[118:119] op_sel_hi:[0,1,1]
 v_pk_mul_f32 v[116:117], v[164:165], v[116:117]
 v_pk_mul_f32 v[118:119], v[166:167], v[118:119]
 v_cvt_pk_bf16_f32 v168, v116, v117
 v_cvt_pk_bf16_f32 v169, v118, v119
 ds_write_b64 v197, v[168:169] offset:0
 v_pk_fma_f32 v[120:121], v[16:17], v[140:141], v[120:121] op_sel_hi:[0,1,1]
 v_pk_fma_f32 v[122:123], v[16:17], v[142:143], v[122:123] op_sel_hi:[0,1,1]
 v_pk_mul_f32 v[120:121], v[164:165], v[120:121]
 v_pk_mul_f32 v[122:123], v[166:167], v[122:123]
 v_cvt_pk_bf16_f32 v170, v120, v121
 v_cvt_pk_bf16_f32 v171, v122, v123
 ds_write_b64 v197, v[170:171] offset:768
 v_pk_fma_f32 v[124:125], v[16:17], v[144:145], v[124:125] op_sel_hi:[0,1,1]
 v_pk_fma_f32 v[126:127], v[16:17], v[146:147], v[126:127] op_sel_hi:[0,1,1]
 v_pk_mul_f32 v[124:125], v[164:165], v[124:125]
 v_pk_mul_f32 v[126:127], v[166:167], v[126:127]
 v_cvt_pk_bf16_f32 v172, v124, v125
 v_cvt_pk_bf16_f32 v173, v126, v127
 ds_write_b64 v197, v[172:173] offset:1536
 v_pk_fma_f32 v[128:129], v[16:17], v[148:149], v[128:129] op_sel_hi:[0,1,1]
 v_pk_fma_f32 v[130:131], v[16:17], v[150:151], v[130:131] op_sel_hi:[0,1,1]
 v_pk_mul_f32 v[128:129], v[164:165], v[128:129]
 v_pk_mul_f32 v[130:131], v[166:167], v[130:131]
 v_cvt_pk_bf16_f32 v174, v128, v129
 v_cvt_pk_bf16_f32 v175, v130, v131
 ds_write_b64 v197, v[174:175] offset:2304
 v_pk_fma_f32 v[132:133], v[16:17], v[152:153], v[132:133] op_sel_hi:[0,1,1]
 v_pk_fma_f32 v[134:135], v[16:17], v[154:155], v[134:135] op_sel_hi:[0,1,1]
 v_pk_mul_f32 v[132:133], v[164:165], v[132:133]
 v_pk_mul_f32 v[134:135], v[166:167], v[134:135]
 v_cvt_pk_bf16_f32 v176, v132, v133
 v_cvt_pk_bf16_f32 v177, v134, v135
 ds_write_b64 v197, v[176:177] offset:3072
 s_waitcnt lgkmcnt(0)
 s_waitcnt vmcnt(14)
 s_barrier
 ds_read_b128 v[32:35], v198 offset:0
 ds_read_b128 v[36:39], v198 offset:15360
 ds_read_b128 v[40:43], v198 offset:768
 ds_read_b128 v[44:47], v198 offset:16128
 ds_read_b128 v[48:51], v198 offset:1536
 ds_read_b128 v[52:55], v198 offset:16896
 ds_read_b128 v[56:59], v198 offset:2304
 ds_read_b128 v[60:63], v198 offset:17664
 ds_read_b128 v[64:67], v198 offset:3072
 ds_read_b128 v[68:71], v198 offset:18432
 s_add_u32 m0, s39, 4096
 s_add_u32 s48, s48, s63
 buffer_load_dwordx4 v24, s[8:11], s48 offen offset:0 lds
 buffer_load_dwordx4 v25, s[8:11], s48 offen offset:1024 lds
 buffer_load_dwordx4 v26, s[8:11], s48 offen offset:2048 lds
 buffer_load_dwordx4 v27, s[8:11], s48 offen offset:3072 lds
 s_waitcnt lgkmcnt(8)
 v_mfma_f32_16x16x32_bf16 v[116:119], v[32:35], v[232:235], 0
 v_mfma_f32_16x16x32_bf16 v[136:139], v[32:35], v[240:243], 0
 v_mfma_f32_16x16x32_bf16 v[116:119], v[36:39], v[236:239], v[116:119]
 v_mfma_f32_16x16x32_bf16 v[136:139], v[36:39], v[244:247], v[136:139]
 s_waitcnt lgkmcnt(6)
 v_mfma_f32_16x16x32_bf16 v[120:123], v[40:43], v[232:235], 0
 v_mfma_f32_16x16x32_bf16 v[140:143], v[40:43], v[240:243], 0
 v_mfma_f32_16x16x32_bf16 v[120:123], v[44:47], v[236:239], v[120:123]
 v_mfma_f32_16x16x32_bf16 v[140:143], v[44:47], v[244:247], v[140:143]
 s_waitcnt lgkmcnt(4)
 v_mfma_f32_16x16x32_bf16 v[124:127], v[48:51], v[232:235], 0
 v_mfma_f32_16x16x32_bf16 v[144:147], v[48:51], v[240:243], 0
 v_mfma_f32_16x16x32_bf16 v[124:127], v[52:55], v[236:239], v[124:127]
 v_mfma_f32_16x16x32_bf16 v[144:147], v[52:55], v[244:247], v[144:147]
 v_pk_add_f32 v[116:117], v[116:117], v[136:137] op_sel:[0,1] op_sel_hi:[1,0] neg_hi:[0,1]
 v_pk_add_f32 v[118:119], v[118:119], v[138:139] op_sel:[0,1] op_sel_hi:[1,0] neg_hi:[0,1]
 v_cvt_pk_bf16_f32 v168, v116, v117
 v_cvt_pk_bf16_f32 v169, v118, v119
 ds_write_b64 v199, v[168:169] offset:3840
 s_waitcnt lgkmcnt(3)
 v_mfma_f32_16x16x32_bf16 v[128:131], v[56:59], v[232:235], 0
 v_mfma_f32_16x16x32_bf16 v[148:151], v[56:59], v[240:243], 0
 v_mfma_f32_16x16x32_bf16 v[128:131], v[60:63], v[236:239], v[128:131]
 v_mfma_f32_16x16x32_bf16 v[148:151], v[60:63], v[244:247], v[148:151]
 v_pk_add_f32 v[120:121], v[120:121], v[140:141] op_sel:[0,1] op_sel_hi:[1,0] neg_hi:[0,1]
 v_pk_add_f32 v[122:123], v[122:123], v[142:143] op_sel:[0,1] op_sel_hi:[1,0] neg_hi:[0,1]
 v_cvt_pk_bf16_f32 v170, v120, v121
 v_cvt_pk_bf16_f32 v171, v122, v123
 ds_write_b64 v199, v[170:171] offset:3872
 s_waitcnt lgkmcnt(2)
 v_mfma_f32_16x16x32_bf16 v[132:135], v[64:67], v[232:235], 0
 v_mfma_f32_16x16x32_bf16 v[152:155], v[64:67], v[240:243], 0
 v_mfma_f32_16x16x32_bf16 v[132:135], v[68:71], v[236:239], v[132:135]
 v_mfma_f32_16x16x32_bf16 v[152:155], v[68:71], v[244:247], v[152:155]
 v_pk_add_f32 v[124:125], v[124:125], v[144:145] op_sel:[0,1] op_sel_hi:[1,0] neg_hi:[0,1]
 v_pk_add_f32 v[126:127], v[126:127], v[146:147] op_sel:[0,1] op_sel_hi:[1,0] neg_hi:[0,1]
 v_cvt_pk_bf16_f32 v172, v124, v125
 v_cvt_pk_bf16_f32 v173, v126, v127
 ds_write_b64 v199, v[172:173] offset:3904
 v_pk_add_f32 v[128:129], v[128:129], v[148:149] op_sel:[0,1] op_sel_hi:[1,0] neg_hi:[0,1]
 v_pk_add_f32 v[130:131], v[130:131], v[150:151] op_sel:[0,1] op_sel_hi:[1,0] neg_hi:[0,1]
 v_cvt_pk_bf16_f32 v174, v128, v129
 v_cvt_pk_bf16_f32 v175, v130, v131
 ds_write_b64 v199, v[174:175] offset:3936
 ds_read_b128 v[72:75], v201 offset:3840
 ds_read_b128 v[76:79], v201 offset:4992
 v_pk_add_f32 v[132:133], v[132:133], v[152:153] op_sel:[0,1] op_sel_hi:[1,0] neg_hi:[0,1]
 v_pk_add_f32 v[134:135], v[134:135], v[154:155] op_sel:[0,1] op_sel_hi:[1,0] neg_hi:[0,1]
 v_cvt_pk_bf16_f32 v176, v132, v133
 v_cvt_pk_bf16_f32 v177, v134, v135
 ds_write_b64 v200, v[176:177] offset:6144
 ds_read_b128 v[80:83], v31 offset:6144
 s_waitcnt lgkmcnt(3)
 buffer_store_dwordx4 v[72:75], v202, s[16:19], s42 offen sc1
 s_waitcnt lgkmcnt(2)
 buffer_store_dwordx4 v[76:79], v202, s[16:19], s41 offen sc1
 s_waitcnt lgkmcnt(0)
 s_mov_b32 exec_hi, 0
 buffer_store_dwordx4 v[80:83], v203, s[16:19], s43 offen sc1
 s_mov_b32 exec_hi, -1
 ds_read_b64_tr_b16 a[32:33], v184 offset:8192
 ds_read_b64_tr_b16 a[34:35], v184 offset:8704
 ds_read_b64_tr_b16 a[36:37], v184 offset:10240
 ds_read_b64_tr_b16 a[38:39], v184 offset:10752
 ds_read_b64_tr_b16 a[40:41], v185 offset:8192
 ds_read_b64_tr_b16 a[42:43], v185 offset:8704
 ds_read_b64_tr_b16 a[44:45], v185 offset:10240
 ds_read_b64_tr_b16 a[46:47], v185 offset:10752
 s_cmp_eq_u32 s3, 3
 s_cselect_b32 s42, 55, 64
 s_add_u32 s72, s39, 81920
 s_mul_i32 s68, s47, s62
 s_add_u32 s68, s68, s54
 s_lshl_b32 s69, s55, 6
 s_lshl_b32 s43, s55, 8
 s_add_u32 s43, s43, s68
 s_add_u32 s43, s43, 3072
 v_add_u32 v23, s43, v27
 v_cmp_lt_u32 vcc, s42, v0
 s_add_u32 s45, s44, 256
 s_mov_b32 s70, s45
 s_add_u32 s68, s68, s45
 v_cndmask_b32 v23, v23, v204, vcc
 s_mul_i32 s42, s46, 20480
 s_add_u32 s42, s42, 81920
 v_add_u32 v13, s42, v186
 s_sub_u32 s50, 64, s36
 s_cmp_eq_u32 s36, 0
 s_cselect_b32 s50, 32, s50
 s_cselect_b32 s52, 0, 1
 s_cmp_eq_u32 s47, 0
 s_cselect_b32 s51, s36, s50
 s_xor_b32 s52, s52, s47
 s_cmp_eq_u32 s51, 0
 s_cselect_b32 s53, 32, 31
 s_lshl_b32 s42, s46, 10
 s_add_u32 s42, s42, s51
 s_mul_i32 s42, s42, 1280
 s_lshl_b32 s41, s3, 12
 s_add_u32 s41, s41, 81920
 v_xor_b32 v64, v1, v2
 v_and_b32 v64, 1, v64
 v_subrev_u32 v64, 1, v64
 v_and_b32 v64, 0x3f803f80, v64
 v_accvgpr_write_b32 a244, v64
 v_accvgpr_write_b32 a245, v64
 v_accvgpr_write_b32 a246, v64
 v_accvgpr_write_b32 a247, v64
 v_mul_u32_u24 v64, 81920, v2

 s_mov_b32 s43, 0
 v_add3_u32 v8, v64, v8, s43
 s_mov_b32 s43, 326656
 v_add3_u32 v9, v64, v9, s43
 s_mov_b32 s43, 653312
 v_add3_u32 v10, v64, v10, s43
 s_mov_b32 s43, 979968
 v_add3_u32 v11, v64, v11, s43
 s_waitcnt vmcnt(3) lgkmcnt(0)
 s_barrier
 ds_read_b64_tr_b16 a[48:49], v184 offset:12288
 ds_read_b64_tr_b16 a[50:51], v184 offset:12800
 ds_read_b64_tr_b16 a[52:53], v184 offset:14336
 ds_read_b64_tr_b16 a[54:55], v184 offset:14848
 ds_read_b64_tr_b16 a[56:57], v185 offset:12288
 ds_read_b64_tr_b16 a[58:59], v185 offset:12800
 ds_read_b64_tr_b16 a[60:61], v185 offset:14336
 ds_read_b64_tr_b16 a[62:63], v185 offset:14848
 ds_read_b64_tr_b16 a[64:65], v184 offset:16384
 ds_read_b64_tr_b16 a[66:67], v184 offset:16896
 ds_read_b64_tr_b16 a[68:69], v184 offset:18432
 ds_read_b64_tr_b16 a[70:71], v184 offset:18944
 ds_read_b64_tr_b16 a[72:73], v185 offset:16384
 ds_read_b64_tr_b16 a[74:75], v185 offset:16896
 ds_read_b64_tr_b16 a[76:77], v185 offset:18432
 ds_read_b64_tr_b16 a[78:79], v185 offset:18944
 ds_read_b64_tr_b16 a[80:81], v184 offset:0
 ds_read_b64_tr_b16 a[82:83], v184 offset:512
 ds_read_b64_tr_b16 a[84:85], v184 offset:2048
 ds_read_b64_tr_b16 a[86:87], v184 offset:2560
 ds_read_b64_tr_b16 a[88:89], v185 offset:0
 ds_read_b64_tr_b16 a[90:91], v185 offset:512
 ds_read_b64_tr_b16 a[92:93], v185 offset:2048
 ds_read_b64_tr_b16 a[94:95], v185 offset:2560
 ds_read_b64_tr_b16 a[96:97], v184 offset:4096
 ds_read_b64_tr_b16 a[98:99], v184 offset:4608
 ds_read_b64_tr_b16 a[100:101], v184 offset:6144
 ds_read_b64_tr_b16 a[102:103], v184 offset:6656
 ds_read_b64_tr_b16 a[104:105], v185 offset:4096
 ds_read_b64_tr_b16 a[106:107], v185 offset:4608
 ds_read_b64_tr_b16 a[108:109], v185 offset:6144
 ds_read_b64_tr_b16 a[110:111], v185 offset:6656
 s_add_u32 m0, s39, 8192
 s_add_u32 s48, s48, s62
 buffer_load_dwordx4 v24, s[8:11], s48 offen offset:0 lds
 s_mov_b32 s26, 3072
 s_mov_b32 s27, 0x20000
 s_mov_b32 s30, 1280
 s_mov_b32 s31, 0x20000
 s_mov_b32 s34, 2621440
 buffer_load_dwordx4 v25, s[8:11], s48 offen offset:1024 lds
 s_mov_b32 s35, 0x20000
 v_lshlrev_b32 v64, 6, v1
 s_lshl_b32 s38, s46, 10
 s_add_u32 s38, s38, s51
 v_add_u32 v64, s38, v64
 buffer_load_dwordx4 v26, s[8:11], s48 offen offset:2048 lds
 v_xor_b32 v65, 0x400, v64
 v_cvt_f32_u32 v64, v64
 v_cvt_f32_u32 v65, v65
 v_mul_f32 v64, 0x3a000000, v64
 v_mul_f32 v65, 0x3a000000, v65
 buffer_load_dwordx4 v27, s[8:11], s48 offen offset:3072 lds
 v_lshlrev_b32 v66, 2, v2
 v_cvt_f32_u32 v66, v66
 v_mul_f32 v67, v64, v66
 v_cos_f32 v32, v67
 v_sin_f32 v33, v67
 v_mfma_f32_16x16x32_bf16 a[240:243], a[0:3], a[244:247], 0
 v_mfma_f32_16x16x32_bf16 a[240:243], a[4:7], a[244:247], a[240:243]
 v_mfma_f32_16x16x32_bf16 a[240:243], a[8:11], a[244:247], a[240:243]
 v_mfma_f32_16x16x32_bf16 a[240:243], a[12:15], a[244:247], a[240:243]
 v_fmamk_f32 v35, v64, 0x3f800000, v67
 v_cos_f32 v34, v35
 v_sin_f32 v35, v35
 v_fmamk_f32 v37, v64, 0x40000000, v67
 v_cos_f32 v36, v37
 v_sin_f32 v37, v37
 v_fmamk_f32 v39, v64, 0x40400000, v67
 v_cos_f32 v38, v39
 v_sin_f32 v39, v39
 v_fmamk_f32 v41, v64, 0x41800000, v67
 v_cos_f32 v40, v41
 v_sin_f32 v41, v41
 v_fmamk_f32 v43, v64, 0x41880000, v67
 v_cos_f32 v42, v43
 v_sin_f32 v43, v43
 v_fmamk_f32 v45, v64, 0x41900000, v67
 v_cos_f32 v44, v45
 v_sin_f32 v45, v45
 v_fmamk_f32 v47, v64, 0x41980000, v67
 v_cos_f32 v46, v47
 v_sin_f32 v47, v47
 s_nop 0
 v_cvt_pk_bf16_f32 v232, v32, v33
 v_cvt_pk_bf16_f32 v233, v34, v35
 v_cvt_pk_bf16_f32 v234, v36, v37
 v_cvt_pk_bf16_f32 v235, v38, v39
 v_cvt_pk_bf16_f32 v236, v40, v41
 v_cvt_pk_bf16_f32 v237, v42, v43
 v_cvt_pk_bf16_f32 v238, v44, v45
 v_cvt_pk_bf16_f32 v239, v46, v47
 v_mul_f32 v67, v65, v66
 v_cos_f32 v32, v67
 v_sin_f32 v33, v67
 v_fmamk_f32 v35, v65, 0x3f800000, v67
 v_cos_f32 v34, v35
 v_sin_f32 v35, v35
 v_fmamk_f32 v37, v65, 0x40000000, v67
 v_cos_f32 v36, v37
 v_sin_f32 v37, v37
 v_fmamk_f32 v39, v65, 0x40400000, v67
 v_mfma_f32_16x16x32_bf16 a[240:243], a[16:19], a[244:247], a[240:243]
 v_mfma_f32_16x16x32_bf16 a[240:243], a[20:23], a[244:247], a[240:243]
 v_mfma_f32_16x16x32_bf16 a[240:243], a[24:27], a[244:247], a[240:243]
 v_mfma_f32_16x16x32_bf16 a[240:243], a[28:31], a[244:247], a[240:243]
 v_mfma_f32_16x16x32_bf16 a[240:243], a[32:35], a[244:247], a[240:243]
 v_mfma_f32_16x16x32_bf16 a[240:243], a[36:39], a[244:247], a[240:243]
 v_mfma_f32_16x16x32_bf16 a[240:243], a[40:43], a[244:247], a[240:243]
 v_mfma_f32_16x16x32_bf16 a[240:243], a[44:47], a[244:247], a[240:243]
 s_waitcnt lgkmcnt(15)
 v_mfma_f32_16x16x32_bf16 a[240:243], a[48:51], a[244:247], a[240:243]
 v_mfma_f32_16x16x32_bf16 a[240:243], a[52:55], a[244:247], a[240:243]
 v_mfma_f32_16x16x32_bf16 a[240:243], a[56:59], a[244:247], a[240:243]
 v_mfma_f32_16x16x32_bf16 a[240:243], a[60:63], a[244:247], a[240:243]
 s_waitcnt lgkmcnt(0)
 s_waitcnt vmcnt(4)
 s_mov_b32 s54, 0
FZ_TAGLOOP:
 v_readfirstlane_b32 s60, v252
 v_readfirstlane_b32 s61, v253
 s_add_u32 s54, s54, 1
 s_cmp_lg_u32 s60, 0
 s_cbranch_scc1 FZ_TAGOK
 s_cmp_gt_u32 s54, 200000
 s_cbranch_scc1 FZ_TAGOK
 buffer_load_dwordx2 v[252:253], v30, s[20:23], 0 offen sc1
 s_waitcnt vmcnt(0)
 s_branch FZ_TAGLOOP

FZ_TAGOK:
 s_barrier
 s_cmp_lg_u32 s3, 0
 s_cbranch_scc1 FZ_NOSIG1
 s_lshl_b32 s54, s2, 7
 s_add_u32 s54, s54, 11534336
 v_mov_b32 v84, s60
 v_mov_b32 v85, s61
 v_mov_b32 v86, s60
 v_mov_b32 v87, s61
 s_mov_b64 exec, 0xff
 buffer_store_dwordx4 v[84:87], v3, s[16:19], s54 offen sc1
 s_mov_b64 exec, -1

FZ_NOSIG1:
 s_add_u32 m0, s39, 12288
 s_add_u32 s48, s48, s63
 buffer_load_dwordx4 v24, s[8:11], s48 offen offset:0 lds
 v_cos_f32 v38, v39
 v_sin_f32 v39, v39
 v_fmamk_f32 v41, v65, 0x41800000, v67
 v_cos_f32 v40, v41
 v_sin_f32 v41, v41
 buffer_load_dwordx4 v25, s[8:11], s48 offen offset:1024 lds
 v_fmamk_f32 v43, v65, 0x41880000, v67
 v_cos_f32 v42, v43
 v_sin_f32 v43, v43
 v_fmamk_f32 v45, v65, 0x41900000, v67
 v_cos_f32 v44, v45
 buffer_load_dwordx4 v26, s[8:11], s48 offen offset:2048 lds
 v_sin_f32 v45, v45
 v_fmamk_f32 v47, v65, 0x41980000, v67
 v_cos_f32 v46, v47
 v_sin_f32 v47, v47
 s_nop 0
 buffer_load_dwordx4 v27, s[8:11], s48 offen offset:3072 lds
 v_cvt_pk_bf16_f32 v240, v32, v33
 v_cvt_pk_bf16_f32 v241, v34, v35
 v_cvt_pk_bf16_f32 v242, v36, v37
 v_cvt_pk_bf16_f32 v243, v38, v39
 v_cvt_pk_bf16_f32 v244, v40, v41
 v_mfma_f32_16x16x32_bf16 a[240:243], a[64:67], a[244:247], a[240:243]
 v_mfma_f32_16x16x32_bf16 a[240:243], a[68:71], a[244:247], a[240:243]
 v_mfma_f32_16x16x32_bf16 a[240:243], a[72:75], a[244:247], a[240:243]
 v_mfma_f32_16x16x32_bf16 a[240:243], a[76:79], a[244:247], a[240:243]
 s_add_u32 m0, s39, 16384
 s_add_u32 s48, s48, s62
 buffer_load_dwordx4 v24, s[8:11], s48 offen offset:0 lds
 v_cvt_pk_bf16_f32 v245, v42, v43
 v_cvt_pk_bf16_f32 v246, v44, v45
 v_cvt_pk_bf16_f32 v247, v46, v47
 v_lshrrev_b32 v64, 2, v1
 v_cmp_eq_u32 vcc, v64, v2
 buffer_load_dwordx4 v25, s[8:11], s48 offen offset:1024 lds
 v_mov_b32 v65, 0x3f80
 v_and_b32 v64, 3, v1
 v_cndmask_b32 v65, 0, v65, vcc
 v_and_b32 v66, 1, v1
 v_xor_b32 v66, 1, v66
 buffer_load_dwordx4 v26, s[8:11], s48 offen offset:2048 lds
 v_lshlrev_b32 v66, 4, v66
 v_lshlrev_b32 v65, v66, v65
 v_add_u32 v66, 1, v64
 v_lshrrev_b32 v66, 1, v66
 v_cmp_eq_u32 vcc, 0, v66
 s_add_u32 m0, s39, 19456
 s_nop 0
 buffer_load_dwordx4 v22, s[8:11], s56 offen lds
 v_mov_b32 v225, 0
 v_mov_b32 v226, 0
 v_cndmask_b32 v222, 0, v65, vcc
 v_cmp_eq_u32 vcc, 1, v66
 v_mov_b32 v227, 0
 v_mfma_f32_16x16x32_bf16 a[240:243], a[80:83], a[244:247], a[240:243]
 v_mfma_f32_16x16x32_bf16 a[240:243], a[84:87], a[244:247], a[240:243]
 v_mfma_f32_16x16x32_bf16 a[240:243], a[88:91], a[244:247], a[240:243]
 v_mfma_f32_16x16x32_bf16 a[240:243], a[92:95], a[244:247], a[240:243]
 s_add_u32 m0, s41, 0
 s_nop 0
 buffer_load_dwordx4 v8, s[4:7], s42 offen offset:0 lds
 v_mov_b32 v230, 0
 v_cndmask_b32 v223, 0, v65, vcc
 v_cmp_eq_u32 vcc, 2, v66
 v_mov_b32 v231, 0
 s_nop 0
 v_cndmask_b32 v224, 0, v65, vcc
 buffer_load_dwordx4 v9, s[4:7], s42 offen offset:1024 lds
 v_cmp_lt_u32 vcc, 1, v64
 s_nop 1
 v_cndmask_b32 v228, 0, v65, vcc
 v_cndmask_b32 v229, v65, 0, vcc
 v_mul_u32_u24 v12, 5120, v2
 v_lshl_add_u32 v12, v1, 4, v12
 buffer_load_dwordx4 v10, s[4:7], s42 offen offset:2048 lds
 v_min_u32 v15, 19, v0
 v_lshlrev_b32 v15, 7, v15
 s_lshl_b32 s59, s37, 2
 s_add_u32 s59, s59, s3
 s_mul_i32 s59, s59, 2560
 s_mul_i32 s38, s36, 81920
 buffer_load_dwordx4 v11, s[4:7], s42 offen offset:3072 lds
 s_add_u32 s59, s59, s38
 s_mul_i32 s58, s47, 40960
 s_add_u32 s58, s58, s38
 s_lshl_b32 s40, s46, 8
 s_add_u32 s40, s40, s58
 s_lshl_b32 s38, s3, 4
 s_add_u32 m0, s41, 16384
 s_add_u32 s42, s42, 256
 buffer_load_dwordx4 v8, s[4:7], s42 offen offset:0 lds
 v_add_u32 v64, s38, v1
 s_lshl_b32 s38, s46, 4
 s_sub_u32 s38, s53, s38
 v_sub_u32 v65, s38, v1
 v_and_b32 v65, 31, v65
 s_lshl_b32 s38, s52, 5
 buffer_load_dwordx4 v9, s[4:7], s42 offen offset:1024 lds
 v_add_u32 v65, s38, v65
 v_lshlrev_b32 v66, 8, v64
 v_lshl_add_u32 v66, v1, 4, v66
 v_and_b32 v68, 15, v65
 v_lshlrev_b32 v67, 8, v65
 v_lshl_add_u32 v67, v68, 4, v67
 buffer_load_dwordx4 v10, s[4:7], s42 offen offset:2048 lds
 v_lshlrev_b32 v69, 1, v2
 s_lshl_b32 s43, s46, 3
 v_add3_u32 v70, v69, s43, 0
 v_and_b32 v71, 15, v70
 v_lshlrev_b32 v71, 4, v71
 v_lshrrev_b32 v70, 4, v70
 buffer_load_dwordx4 v11, s[4:7], s42 offen offset:3072 lds
 v_lshl_or_b32 v71, v70, 14, v71
 v_xor_b32 v71, v71, v66
 v_add_u32 v207, 81920, v71
 v_add_u32 v70, 32, v69
 v_and_b32 v71, 15, v70
 v_lshlrev_b32 v71, 4, v71
 s_add_u32 m0, s41, 32768
 s_add_u32 s42, s42, 256
 buffer_load_dwordx4 v8, s[4:7], s42 offen offset:0 lds
 v_lshrrev_b32 v70, 4, v70
 v_lshl_or_b32 v71, v70, 14, v71
 v_xor_b32 v71, v71, v66
 v_add_u32 v217, 81920, v71
 v_add3_u32 v70, v69, s43, 1
 v_and_b32 v71, 15, v70
 buffer_load_dwordx4 v9, s[4:7], s42 offen offset:1024 lds
 v_lshlrev_b32 v71, 4, v71
 v_lshrrev_b32 v70, 4, v70
 v_lshl_or_b32 v71, v70, 14, v71
 v_xor_b32 v71, v71, v66
 v_add_u32 v208, 81920, v71
 v_add_u32 v70, 33, v69
 buffer_load_dwordx4 v10, s[4:7], s42 offen offset:2048 lds
 v_and_b32 v71, 15, v70
 v_lshlrev_b32 v71, 4, v71
 v_lshrrev_b32 v70, 4, v70
 v_lshl_or_b32 v71, v70, 14, v71
 v_xor_b32 v71, v71, v66
 v_add_u32 v218, 81920, v71
 buffer_load_dwordx4 v11, s[4:7], s42 offen offset:3072 lds
 v_add3_u32 v70, v69, s43, 2
 v_and_b32 v71, 15, v70
 v_lshlrev_b32 v71, 4, v71
 v_lshrrev_b32 v70, 4, v70
 v_lshl_or_b32 v71, v70, 14, v71
 v_xor_b32 v71, v71, v66
 s_add_u32 m0, s41, 49152
 s_add_u32 s42, s42, 256
 buffer_load_dwordx4 v8, s[4:7], s42 offen offset:0 lds
 v_add_u32 v209, 81920, v71
 v_add_u32 v70, 34, v69
 v_and_b32 v71, 15, v70
 v_lshlrev_b32 v71, 4, v71
 v_lshrrev_b32 v70, 4, v70
 v_lshl_or_b32 v71, v70, 14, v71
 buffer_load_dwordx4 v9, s[4:7], s42 offen offset:1024 lds
 v_xor_b32 v71, v71, v66
 v_add_u32 v219, 81920, v71
 s_sub_u32 s38, 62, s43
 v_sub_u32 v70, s38, v69
 v_and_b32 v71, 15, v70
 v_lshlrev_b32 v71, 4, v71
 buffer_load_dwordx4 v10, s[4:7], s42 offen offset:2048 lds
 v_lshrrev_b32 v70, 4, v70
 v_lshl_or_b32 v71, v70, 14, v71
 v_xor_b32 v71, v71, v67
 v_add_u32 v210, 81920, v71
 v_sub_u32 v70, 46, v69
 v_and_b32 v71, 15, v70
 buffer_load_dwordx4 v11, s[4:7], s42 offen offset:3072 lds
 v_lshlrev_b32 v71, 4, v71
 v_lshrrev_b32 v70, 4, v70
 v_lshl_or_b32 v71, v70, 14, v71
 v_xor_b32 v71, v71, v67
 v_add_u32 v220, 81920, v71
 s_sub_u32 s38, 63, s43
 s_add_u32 m0, s41, 65536
 s_add_u32 s42, s42, 256
 buffer_load_dwordx4 v8, s[4:7], s42 offen offset:0 lds
 v_sub_u32 v70, s38, v69
 v_and_b32 v71, 15, v70
 v_lshlrev_b32 v71, 4, v71
 v_lshrrev_b32 v70, 4, v70
 v_lshl_or_b32 v71, v70, 14, v71
 v_xor_b32 v71, v71, v67
 buffer_load_dwordx4 v9, s[4:7], s42 offen offset:1024 lds
 v_add_u32 v211, 81920, v71
 v_sub_u32 v70, 47, v69
 v_and_b32 v71, 15, v70
 v_lshlrev_b32 v71, 4, v71
 v_lshrrev_b32 v70, 4, v70
 v_lshl_or_b32 v71, v70, 14, v71
 buffer_load_dwordx4 v10, s[4:7], s42 offen offset:2048 lds
 v_xor_b32 v71, v71, v67
 v_add_u32 v221, 81920, v71
 v_xor_b32 v212, 0x1000, v207
 v_xor_b32 v213, 0x1000, v208
 v_xor_b32 v214, 0x1000, v209
 v_xor_b32 v215, 0x1000, v210
 buffer_load_dwordx4 v11, s[4:7], s42 offen offset:3072 lds
 v_xor_b32 v216, 0x1000, v211
 v_add_u32 v206, 81920, v67
 s_lshl_b32 s38, s3, 10
 v_add_u32 v20, s38, v3
 v_lshrrev_b32 v70, 4, v65
 v_lshlrev_b32 v70, 10, v70
 v_lshl_add_u32 v70, v2, 8, v70
 v_lshl_add_u32 v70, v68, 4, v70
 v_add_u32 v21, 40960, v70
 s_lshl_b32 s38, s46, 13
 v_add_u32 v16, s38, v20
 v_xor_b32 v17, 0x400, v16
 v_add_u32 v18, s38, v21
 v_xor_b32 v19, 0x400, v18
 v_lshlrev_b32 v14, 7, v0
 s_lshl_b32 s41, s3, 13
 s_add_u32 s41, s41, 11534336
 buffer_load_dwordx2 v[254:255], v14, s[16:19], s41 offen sc1
 v_mfma_f32_16x16x32_bf16 a[240:243], a[96:99], a[244:247], a[240:243]
 v_mfma_f32_16x16x32_bf16 a[240:243], a[100:103], a[244:247], a[240:243]
 v_mfma_f32_16x16x32_bf16 a[240:243], a[104:107], a[244:247], a[240:243]
 v_mfma_f32_16x16x32_bf16 a[240:243], a[108:111], a[244:247], a[240:243]
 s_waitcnt vmcnt(21)
 s_barrier
 ds_read_b64_tr_b16 a[112:113], v184 offset:8192
 ds_read_b64_tr_b16 a[114:115], v184 offset:8704
 ds_read_b64_tr_b16 a[116:117], v184 offset:10240
 ds_read_b64_tr_b16 a[118:119], v184 offset:10752
 ds_read_b64_tr_b16 a[120:121], v185 offset:8192
 ds_read_b64_tr_b16 a[122:123], v185 offset:8704
 ds_read_b64_tr_b16 a[124:125], v185 offset:10240
 ds_read_b64_tr_b16 a[126:127], v185 offset:10752
 ds_read_b64_tr_b16 a[128:129], v184 offset:12288
 ds_read_b64_tr_b16 a[130:131], v184 offset:12800
 ds_read_b64_tr_b16 a[132:133], v184 offset:14336
 ds_read_b64_tr_b16 a[134:135], v184 offset:14848
 ds_read_b64_tr_b16 a[136:137], v185 offset:12288
 ds_read_b64_tr_b16 a[138:139], v185 offset:12800
 ds_read_b64_tr_b16 a[140:141], v185 offset:14336
 ds_read_b64_tr_b16 a[142:143], v185 offset:14848
 ds_read_b64_tr_b16 a[144:145], v184 offset:16384
 ds_read_b64_tr_b16 a[146:147], v184 offset:16896
 ds_read_b64_tr_b16 a[148:149], v184 offset:18432
 ds_read_b64_tr_b16 a[150:151], v184 offset:18944
 ds_read_b64_tr_b16 a[152:153], v185 offset:16384
 ds_read_b64_tr_b16 a[154:155], v185 offset:16896
 ds_read_b64_tr_b16 a[156:157], v185 offset:18432
 ds_read_b64_tr_b16 a[158:159], v185 offset:18944
 s_mov_b32 s42, s40
 s_mov_b32 s43, s58
 s_mov_b32 s63, s59
 s_mul_i32 s40, s46, 40960
 s_sub_u32 s62, 40960, s40
 s_lshl_b32 s48, s3, 6
 s_add_u32 s44, s44, s48
 s_lshl_b32 s48, s47, 6
 s_add_u32 s45, s45, s48
 s_xor_b32 s48, s3, 0
 s_lshl_b32 s54, s48, 10
 s_xor_b32 s48, s3, 1
 s_lshl_b32 s55, s48, 10
 s_xor_b32 s48, s3, 2
 s_lshl_b32 s56, s48, 10
 s_xor_b32 s48, s3, 3
 s_lshl_b32 s57, s48, 10
 v_and_b32 v10, 16, v0
 v_lshlrev_b32 v10, 6, v10
 v_and_b32 v22, 32, v0
 v_lshl_add_u32 v10, v22, 3, v10
 v_lshl_add_u32 v10, v1, 4, v10
 s_lshl_b32 s48, s46, 11
 v_add_u32 v22, s48, v10
 v_add_u32 v4, s40, v22
 v_add_u32 v6, s62, v22
 v_xor_b32 v5, 0x800, v4
 v_xor_b32 v7, 0x800, v6
 v_add_u32 v22, s54, v3
 v_add_u32 v8, s40, v22
 v_add_u32 v9, s62, v22
 v_mov_b32 v11, v13

 s_mul_i32 s48, s37, 245760
 s_mul_i32 s49, s3, 61440
 s_add_u32 s48, s48, s49
 s_add_u32 s48, s48, 3145728
 s_mul_i32 s49, s3, 49152
 s_mov_b32 s4, s42
 s_add_u32 s5, s42, 20480
 s_add_u32 s6, s42, 512
 s_add_u32 s7, s42, 20992
 s_add_u32 s22, s43, 1024
 s_add_u32 s23, s43, 21504

 s_waitcnt lgkmcnt(15)
 v_mfma_f32_16x16x32_bf16 a[240:243], a[112:115], a[244:247], a[240:243]
 v_mfma_f32_16x16x32_bf16 a[240:243], a[116:119], a[244:247], a[240:243]
 v_mfma_f32_16x16x32_bf16 a[240:243], a[120:123], a[244:247], a[240:243]
 v_mfma_f32_16x16x32_bf16 a[240:243], a[124:127], a[244:247], a[240:243]
 s_waitcnt lgkmcnt(8)
 v_mfma_f32_16x16x32_bf16 a[240:243], a[128:131], a[244:247], a[240:243]
 v_mfma_f32_16x16x32_bf16 a[240:243], a[132:135], a[244:247], a[240:243]
 v_mfma_f32_16x16x32_bf16 a[240:243], a[136:139], a[244:247], a[240:243]
 v_mfma_f32_16x16x32_bf16 a[240:243], a[140:143], a[244:247], a[240:243]
 s_waitcnt lgkmcnt(0)
 v_mfma_f32_16x16x32_bf16 a[240:243], a[144:147], a[244:247], a[240:243]
 v_mfma_f32_16x16x32_bf16 a[240:243], a[148:151], a[244:247], a[240:243]
 v_mfma_f32_16x16x32_bf16 a[240:243], a[152:155], a[244:247], a[240:243]
 v_mfma_f32_16x16x32_bf16 a[240:243], a[156:159], a[244:247], a[240:243]
 s_mov_b32 s62, 0
FZ_POLL1:
 s_waitcnt vmcnt(0)
 v_cmp_ne_u64 vcc, s[60:61], v[254:255]
 s_add_u32 s62, s62, 1
 s_cmp_eq_u64 vcc, 0
 s_cbranch_scc1 FZ_POLL1OK
 s_cmp_gt_u32 s62, 200000
 s_cbranch_scc1 FZ_POLL1OK
 buffer_load_dwordx2 v[254:255], v14, s[16:19], s41 offen sc1
 s_branch FZ_POLL1

FZ_POLL1OK:
 s_barrier
 s_mov_b64 exec, 0xfffff
 buffer_load_dword v255, v15, s[16:19], s63 offen sc1
 s_mov_b64 exec, -1
 buffer_load_dwordx4 v[32:35], v12, s[16:19], s4 offen offset:0 sc1
 buffer_load_dwordx4 v[36:39], v12, s[16:19], s4 offen offset:1280 sc1
 buffer_load_dwordx4 v[40:43], v12, s[16:19], s4 offen offset:2560 sc1
 buffer_load_dwordx4 v[44:47], v12, s[16:19], s4 offen offset:3840 sc1
 buffer_load_dwordx4 v[48:51], v12, s[16:19], s5 offen offset:0 sc1
 buffer_load_dwordx4 v[52:55], v12, s[16:19], s5 offen offset:1280 sc1
 buffer_load_dwordx4 v[56:59], v12, s[16:19], s5 offen offset:2560 sc1
 buffer_load_dwordx4 v[60:63], v12, s[16:19], s5 offen offset:3840 sc1
 ds_read_u16 v22, v206
 buffer_load_dwordx4 v[64:67], v12, s[16:19], s6 offen offset:0 sc1
 buffer_load_dwordx4 v[68:71], v12, s[16:19], s6 offen offset:1280 sc1
 ds_read_b128 a[160:163], v207 offset:0
 ds_read_b128 a[164:167], v208 offset:0
 ds_read_b64 a[168:169], v209 offset:0
 ds_read_b128 a[170:173], v210 offset:16384
 ds_read_b128 a[174:177], v211 offset:16384
 ds_read_b128 a[178:181], v212 offset:0
 ds_read_b128 a[182:185], v213 offset:0
 ds_read_b64 a[186:187], v214 offset:0
 ds_read_b128 a[188:191], v215 offset:16384
 ds_read_b128 a[192:195], v216 offset:16384
 ds_read_b128 a[196:199], v207 offset:16384
 ds_read_b128 a[200:203], v208 offset:16384
 ds_read_b64 a[204:205], v209 offset:16384
 ds_read_b128 a[206:209], v210 offset:0
 ds_read_b128 a[210:213], v211 offset:0
 ds_read_b128 a[214:217], v212 offset:16384
 ds_read_b128 a[218:221], v213 offset:16384
 ds_read_b64 a[222:223], v214 offset:16384
 ds_read_b128 a[224:227], v215 offset:0
 ds_read_b128 a[228:231], v216 offset:0
 ds_read_b128 v[192:195], v217 offset:0
 ds_read_b128 v[196:199], v218 offset:0
 ds_read_b64 v[200:201], v219 offset:0
 ds_read_b128 a[232:235], v220 offset:0
 ds_read_b128 a[236:239], v221 offset:0
 s_mul_i32 s38, s37, 80
 s_sub_u32 s39, 960, s38
 s_sub_u32 s40, s38, 16
 s_cmp_lt_u32 s37, 4
 s_cselect_b32 s38, s40, s39
 s_cselect_b32 s39, 16, -16
 s_lshr_b32 s40, s38, 6
 s_lshl_b32 s40, s40, 13
 s_bfe_u32 s20, s38, 0x20004
 s_lshl_b32 s20, s20, 8
 s_add_u32 s20, s20, s40
 s_add_u32 s38, s38, s39
 s_lshr_b32 s40, s38, 6
 s_lshl_b32 s40, s40, 13
 s_bfe_u32 s21, s38, 0x20004
 s_lshl_b32 s21, s21, 8
 s_add_u32 s21, s21, s40
 s_add_u32 s38, s38, s39
 s_lshr_b32 s40, s38, 6
 s_lshl_b32 s40, s40, 13
 s_bfe_u32 s12, s38, 0x20004
 s_lshl_b32 s12, s12, 8
 s_add_u32 s12, s12, s40
 s_add_u32 s38, s38, s39
 s_lshr_b32 s40, s38, 6
 s_lshl_b32 s40, s40, 13
 s_bfe_u32 s13, s38, 0x20004
 s_lshl_b32 s13, s13, 8
 s_add_u32 s13, s13, s40
 s_add_u32 s38, s38, s39
 s_lshr_b32 s40, s38, 6
 s_lshl_b32 s40, s40, 13
 s_bfe_u32 s14, s38, 0x20004
 s_lshl_b32 s14, s14, 8
 s_add_u32 s14, s14, s40
 s_add_u32 s38, s38, s39
 s_lshr_b32 s40, s38, 6
 s_lshl_b32 s40, s40, 13
 s_bfe_u32 s15, s38, 0x20004
 s_lshl_b32 s15, s15, 8
 s_add_u32 s15, s15, s40
 s_add_u32 s38, s38, s39
 s_cmp_eq_u32 s37, 0
 s_cselect_b32 s20, 74496, s20

 s_waitcnt lgkmcnt(0)
 s_barrier
 s_waitcnt vmcnt(6)
 buffer_load_dwordx4 v[72:75], v12, s[16:19], s6 offen offset:2560 sc1
 buffer_load_dwordx4 v[76:79], v12, s[16:19], s6 offen offset:3840 sc1
 buffer_load_dwordx4 v[80:83], v12, s[16:19], s7 offen offset:0 sc1
 v_swap_b32 v33, v36
 v_swap_b32 v34, v40
 v_swap_b32 v35, v44
 v_swap_b32 v38, v41
 v_swap_b32 v39, v45
 v_swap_b32 v43, v46
 s_waitcnt vmcnt(5)
 buffer_load_dwordx4 v[84:87], v12, s[16:19], s7 offen offset:1280 sc1
 buffer_load_dwordx4 v[88:91], v12, s[16:19], s7 offen offset:2560 sc1
 buffer_load_dwordx4 v[92:95], v12, s[16:19], s7 offen offset:3840 sc1
 v_swap_b32 v49, v52
 v_swap_b32 v50, v56
 v_swap_b32 v51, v60
 v_swap_b32 v54, v57
 v_swap_b32 v55, v61
 v_swap_b32 v59, v62
 v_mfma_f32_16x16x32_bf16 v[128:131], v[32:35], v[232:235], 0
 buffer_load_dwordx4 v[96:99], v12, s[16:19], s22 offen offset:0 sc1
 v_mfma_f32_16x16x32_bf16 v[132:135], v[36:39], v[232:235], 0
 buffer_load_dwordx4 v[100:103], v12, s[16:19], s22 offen offset:1280 sc1
 v_mfma_f32_16x16x32_bf16 v[136:139], v[40:43], v[232:235], 0
 buffer_load_dwordx4 v[104:107], v12, s[16:19], s22 offen offset:2560 sc1
 v_mfma_f32_16x16x32_bf16 v[140:143], v[44:47], v[232:235], 0
 buffer_load_dwordx4 v[108:111], v12, s[16:19], s22 offen offset:3840 sc1
 v_mfma_f32_16x16x32_bf16 v[128:131], v[48:51], v[236:239], v[128:131]
 buffer_load_dwordx4 v[112:115], v12, s[16:19], s23 offen offset:0 sc1
 v_mfma_f32_16x16x32_bf16 v[132:135], v[52:55], v[236:239], v[132:135]
 buffer_load_dwordx4 v[116:119], v12, s[16:19], s23 offen offset:1280 sc1
 v_mfma_f32_16x16x32_bf16 v[136:139], v[56:59], v[236:239], v[136:139]
 buffer_load_dwordx4 v[120:123], v12, s[16:19], s23 offen offset:2560 sc1
 v_mfma_f32_16x16x32_bf16 v[140:143], v[60:63], v[236:239], v[140:143]
 buffer_load_dwordx4 v[124:127], v12, s[16:19], s23 offen offset:3840 sc1
 v_mfma_f32_16x16x32_bf16 v[144:147], v[222:225], a[160:163], v[128:131]
 v_mfma_f32_16x16x32_bf16 v[148:151], v[222:225], a[162:165], v[132:135]
 v_mfma_f32_16x16x32_bf16 v[152:155], v[222:225], a[164:167], v[136:139]
 v_mfma_f32_16x16x32_bf16 v[156:159], v[222:225], a[166:169], v[140:143]
 v_mfma_f32_16x16x32_bf16 v[128:131], v[226:229], a[174:177], v[128:131]
 v_mfma_f32_16x16x32_bf16 v[132:135], v[228:231], a[174:177], v[132:135]
 v_mfma_f32_16x16x32_bf16 v[136:139], v[226:229], a[170:173], v[136:139]
 v_mfma_f32_16x16x32_bf16 v[140:143], v[228:231], a[170:173], v[140:143]
 s_nop 1
 v_mfma_f32_16x16x32_bf16 v[160:163], v[32:35], v[240:243], 0
 v_cvt_pk_bf16_f32 v144, v144, v145
 v_cvt_pk_bf16_f32 v145, v146, v147
 v_mfma_f32_16x16x32_bf16 v[164:167], v[36:39], v[240:243], 0
 v_cvt_pk_bf16_f32 v146, v148, v149
 v_cvt_pk_bf16_f32 v147, v150, v151
 v_mfma_f32_16x16x32_bf16 v[168:171], v[40:43], v[240:243], 0
 s_add_u32 m0, s72, 0
 s_nop 0
 buffer_load_dwordx4 v24, s[8:11], s68 offen offset:0 lds
 v_mfma_f32_16x16x32_bf16 v[172:175], v[44:47], v[240:243], 0
 ds_write_b128 v16, v[144:147] offset:0
 v_cvt_pk_bf16_f32 v148, v152, v153
 v_mfma_f32_16x16x32_bf16 v[160:163], v[48:51], v[244:247], v[160:163]
 v_cvt_pk_bf16_f32 v149, v154, v155
 v_cvt_pk_bf16_f32 v150, v156, v157
 v_mfma_f32_16x16x32_bf16 v[164:167], v[52:55], v[244:247], v[164:167]
 v_cvt_pk_bf16_f32 v151, v158, v159
 ds_write_b128 v16, v[148:151] offset:4096
 v_mfma_f32_16x16x32_bf16 v[168:171], v[56:59], v[244:247], v[168:171]
 v_cvt_pk_bf16_f32 v128, v128, v129
 v_cvt_pk_bf16_f32 v129, v130, v131
 v_mfma_f32_16x16x32_bf16 v[172:175], v[60:63], v[244:247], v[172:175]
 buffer_load_dwordx4 v25, s[8:11], s68 offen offset:1024 lds
 v_mfma_f32_16x16x32_bf16 v[176:179], v[222:225], a[178:181], v[160:163]
 v_cvt_pk_bf16_f32 v130, v132, v133
 v_cvt_pk_bf16_f32 v131, v134, v135
 v_mfma_f32_16x16x32_bf16 v[180:183], v[222:225], a[180:183], v[164:167]
 ds_write_b128 v18, v[128:131] offset:0
 v_cvt_pk_bf16_f32 v132, v136, v137
 v_mfma_f32_16x16x32_bf16 v[184:187], v[222:225], a[182:185], v[168:171]
 v_cvt_pk_bf16_f32 v133, v138, v139
 v_cvt_pk_bf16_f32 v134, v140, v141
 v_mfma_f32_16x16x32_bf16 v[188:191], v[222:225], a[184:187], v[172:175]
 v_cvt_pk_bf16_f32 v135, v142, v143
 ds_write_b128 v18, v[132:135] offset:4096
 v_mfma_f32_16x16x32_bf16 v[160:163], v[226:229], a[192:195], v[160:163]
 buffer_load_dwordx4 v26, s[8:11], s68 offen offset:2048 lds
 v_mfma_f32_16x16x32_bf16 v[164:167], v[228:231], a[192:195], v[164:167]
 s_waitcnt vmcnt(15)
 v_swap_b32 v65, v68
 v_mfma_f32_16x16x32_bf16 v[168:171], v[226:229], a[188:191], v[168:171]
 v_swap_b32 v66, v72
 v_swap_b32 v67, v76
 v_mfma_f32_16x16x32_bf16 v[172:175], v[228:231], a[188:191], v[172:175]
 v_swap_b32 v70, v73
 v_swap_b32 v71, v77
 v_swap_b32 v75, v78
 s_waitcnt vmcnt(11)
 v_swap_b32 v81, v84
 v_swap_b32 v82, v88
 v_swap_b32 v83, v92
 v_swap_b32 v86, v89
 v_swap_b32 v87, v93
 v_swap_b32 v91, v94
 s_nop 1
 v_mfma_f32_16x16x32_bf16 v[128:131], v[64:67], v[232:235], 0
 v_cvt_pk_bf16_f32 v176, v176, v177
 v_cvt_pk_bf16_f32 v177, v178, v179
 v_mfma_f32_16x16x32_bf16 v[132:135], v[68:71], v[232:235], 0
 v_cvt_pk_bf16_f32 v178, v180, v181
 v_cvt_pk_bf16_f32 v179, v182, v183
 v_mfma_f32_16x16x32_bf16 v[136:139], v[72:75], v[232:235], 0
 buffer_load_dwordx4 v27, s[8:11], s68 offen offset:3072 lds
 v_mfma_f32_16x16x32_bf16 v[140:143], v[76:79], v[232:235], 0
 ds_write_b128 v17, v[176:179] offset:0
 v_cvt_pk_bf16_f32 v180, v184, v185
 v_mfma_f32_16x16x32_bf16 v[128:131], v[80:83], v[236:239], v[128:131]
 v_cvt_pk_bf16_f32 v181, v186, v187
 v_cvt_pk_bf16_f32 v182, v188, v189
 v_mfma_f32_16x16x32_bf16 v[132:135], v[84:87], v[236:239], v[132:135]
 v_cvt_pk_bf16_f32 v183, v190, v191
 ds_write_b128 v17, v[180:183] offset:4096
 v_mfma_f32_16x16x32_bf16 v[136:139], v[88:91], v[236:239], v[136:139]
 v_cvt_pk_bf16_f32 v160, v160, v161
 v_cvt_pk_bf16_f32 v161, v162, v163
 v_mfma_f32_16x16x32_bf16 v[140:143], v[92:95], v[236:239], v[140:143]
 s_add_u32 m0, s72, 4096
 s_add_u32 s68, s68, s69
 buffer_load_dwordx4 v24, s[8:11], s68 offen offset:0 lds
 v_mfma_f32_16x16x32_bf16 v[144:147], v[222:225], a[196:199], v[128:131]
 v_cvt_pk_bf16_f32 v162, v164, v165
 v_cvt_pk_bf16_f32 v163, v166, v167
 v_mfma_f32_16x16x32_bf16 v[148:151], v[222:225], a[198:201], v[132:135]
 ds_write_b128 v19, v[160:163] offset:0
 v_cvt_pk_bf16_f32 v164, v168, v169
 v_mfma_f32_16x16x32_bf16 v[152:155], v[222:225], a[200:203], v[136:139]
 v_cvt_pk_bf16_f32 v165, v170, v171
 v_cvt_pk_bf16_f32 v166, v172, v173
 v_mfma_f32_16x16x32_bf16 v[156:159], v[222:225], a[202:205], v[140:143]
 v_cvt_pk_bf16_f32 v167, v174, v175
 ds_write_b128 v19, v[164:167] offset:4096
 v_mfma_f32_16x16x32_bf16 v[128:131], v[226:229], a[210:213], v[128:131]
 buffer_load_dwordx4 v25, s[8:11], s68 offen offset:1024 lds
 v_mfma_f32_16x16x32_bf16 v[132:135], v[228:231], a[210:213], v[132:135]
 v_mfma_f32_16x16x32_bf16 v[136:139], v[226:229], a[206:209], v[136:139]
 v_mfma_f32_16x16x32_bf16 v[140:143], v[228:231], a[206:209], v[140:143]
 s_nop 1
 v_mfma_f32_16x16x32_bf16 v[160:163], v[64:67], v[240:243], 0
 v_cvt_pk_bf16_f32 v144, v144, v145
 v_cvt_pk_bf16_f32 v145, v146, v147
 v_mfma_f32_16x16x32_bf16 v[164:167], v[68:71], v[240:243], 0
 v_cvt_pk_bf16_f32 v146, v148, v149
 v_cvt_pk_bf16_f32 v147, v150, v151
 v_mfma_f32_16x16x32_bf16 v[168:171], v[72:75], v[240:243], 0
 buffer_load_dwordx4 v26, s[8:11], s68 offen offset:2048 lds
 v_mfma_f32_16x16x32_bf16 v[172:175], v[76:79], v[240:243], 0
 ds_write_b128 v16, v[144:147] offset:16384
 v_cvt_pk_bf16_f32 v148, v152, v153
 v_mfma_f32_16x16x32_bf16 v[160:163], v[80:83], v[244:247], v[160:163]
 v_cvt_pk_bf16_f32 v149, v154, v155
 v_cvt_pk_bf16_f32 v150, v156, v157
 v_mfma_f32_16x16x32_bf16 v[164:167], v[84:87], v[244:247], v[164:167]
 v_cvt_pk_bf16_f32 v151, v158, v159
 ds_write_b128 v16, v[148:151] offset:20480
 v_mfma_f32_16x16x32_bf16 v[168:171], v[88:91], v[244:247], v[168:171]
 v_cvt_pk_bf16_f32 v128, v128, v129
 v_cvt_pk_bf16_f32 v129, v130, v131
 v_mfma_f32_16x16x32_bf16 v[172:175], v[92:95], v[244:247], v[172:175]
 buffer_load_dwordx4 v27, s[8:11], s68 offen offset:3072 lds
 v_mfma_f32_16x16x32_bf16 v[176:179], v[222:225], a[214:217], v[160:163]
 v_cvt_pk_bf16_f32 v130, v132, v133
 v_cvt_pk_bf16_f32 v131, v134, v135
 v_mfma_f32_16x16x32_bf16 v[180:183], v[222:225], a[216:219], v[164:167]
 ds_write_b128 v18, v[128:131] offset:16384
 v_cvt_pk_bf16_f32 v132, v136, v137
 v_mfma_f32_16x16x32_bf16 v[184:187], v[222:225], a[218:221], v[168:171]
 v_cvt_pk_bf16_f32 v133, v138, v139
 v_cvt_pk_bf16_f32 v134, v140, v141
 v_mfma_f32_16x16x32_bf16 v[188:191], v[222:225], a[220:223], v[172:175]
 v_cvt_pk_bf16_f32 v135, v142, v143
 ds_write_b128 v18, v[132:135] offset:20480
 v_mfma_f32_16x16x32_bf16 v[160:163], v[226:229], a[228:231], v[160:163]
 s_add_u32 m0, s72, 8192
 s_add_u32 s68, s68, s69
 buffer_load_dwordx4 v24, s[8:11], s68 offen offset:0 lds
 v_mfma_f32_16x16x32_bf16 v[164:167], v[228:231], a[228:231], v[164:167]
 s_waitcnt vmcnt(13)
 v_swap_b32 v97, v100
 v_mfma_f32_16x16x32_bf16 v[168:171], v[226:229], a[224:227], v[168:171]
 v_swap_b32 v98, v104
 v_swap_b32 v99, v108
 v_mfma_f32_16x16x32_bf16 v[172:175], v[228:231], a[224:227], v[172:175]
 v_swap_b32 v102, v105
 v_swap_b32 v103, v109
 v_swap_b32 v107, v110
 s_waitcnt vmcnt(9)
 v_swap_b32 v113, v116
 v_swap_b32 v114, v120
 v_swap_b32 v115, v124
 v_swap_b32 v118, v121
 v_swap_b32 v119, v125
 v_swap_b32 v123, v126
 s_nop 1
 v_mfma_f32_16x16x32_bf16 v[128:131], v[96:99], v[232:235], 0
 v_cvt_pk_bf16_f32 v176, v176, v177
 v_cvt_pk_bf16_f32 v177, v178, v179
 v_mfma_f32_16x16x32_bf16 v[132:135], v[100:103], v[232:235], 0
 v_cvt_pk_bf16_f32 v178, v180, v181
 v_cvt_pk_bf16_f32 v179, v182, v183
 v_mfma_f32_16x16x32_bf16 v[136:139], v[104:107], v[232:235], 0
 buffer_load_dwordx4 v25, s[8:11], s68 offen offset:1024 lds
 v_mfma_f32_16x16x32_bf16 v[140:143], v[108:111], v[232:235], 0
 ds_write_b128 v17, v[176:179] offset:16384
 v_cvt_pk_bf16_f32 v180, v184, v185
 v_mfma_f32_16x16x32_bf16 v[128:131], v[112:115], v[236:239], v[128:131]
 v_cvt_pk_bf16_f32 v181, v186, v187
 v_cvt_pk_bf16_f32 v182, v188, v189
 v_mfma_f32_16x16x32_bf16 v[132:135], v[116:119], v[236:239], v[132:135]
 v_cvt_pk_bf16_f32 v183, v190, v191
 ds_write_b128 v17, v[180:183] offset:20480
 v_mfma_f32_16x16x32_bf16 v[136:139], v[120:123], v[236:239], v[136:139]
 v_cvt_pk_bf16_f32 v160, v160, v161
 v_cvt_pk_bf16_f32 v161, v162, v163
 v_mfma_f32_16x16x32_bf16 v[140:143], v[124:127], v[236:239], v[140:143]
 buffer_load_dwordx4 v26, s[8:11], s68 offen offset:2048 lds
 v_mfma_f32_16x16x32_bf16 v[144:147], v[222:225], v[192:195], v[128:131]
 v_cvt_pk_bf16_f32 v162, v164, v165
 v_cvt_pk_bf16_f32 v163, v166, v167
 v_mfma_f32_16x16x32_bf16 v[148:151], v[222:225], v[194:197], v[132:135]
 ds_write_b128 v19, v[160:163] offset:16384
 v_cvt_pk_bf16_f32 v164, v168, v169
 v_mfma_f32_16x16x32_bf16 v[152:155], v[222:225], v[196:199], v[136:139]
 v_cvt_pk_bf16_f32 v165, v170, v171
 v_cvt_pk_bf16_f32 v166, v172, v173
 v_mfma_f32_16x16x32_bf16 v[156:159], v[222:225], v[198:201], v[140:143]
 v_cvt_pk_bf16_f32 v167, v174, v175
 ds_write_b128 v19, v[164:167] offset:20480
 v_mfma_f32_16x16x32_bf16 v[128:131], v[226:229], a[236:239], v[128:131]
 buffer_load_dwordx4 v27, s[8:11], s68 offen offset:3072 lds
 v_mfma_f32_16x16x32_bf16 v[132:135], v[228:231], a[236:239], v[132:135]
 v_mfma_f32_16x16x32_bf16 v[136:139], v[226:229], a[232:235], v[136:139]
 v_mfma_f32_16x16x32_bf16 v[140:143], v[228:231], a[232:235], v[140:143]
 s_nop 1
 v_cvt_pk_bf16_f32 v144, v144, v145
 v_cvt_pk_bf16_f32 v145, v146, v147
 v_cvt_pk_bf16_f32 v146, v148, v149
 v_cvt_pk_bf16_f32 v147, v150, v151
 ds_write_b128 v20, v[144:147] offset:32768
 v_cvt_pk_bf16_f32 v148, v152, v153
 v_cvt_pk_bf16_f32 v149, v154, v155
 v_cvt_pk_bf16_f32 v150, v156, v157
 v_cvt_pk_bf16_f32 v151, v158, v159
 ds_write_b128 v20, v[148:151] offset:36864
 v_cmp_eq_u32 vcc, 3, v2
 v_lshlrev_b32 v22, 16, v22
 s_nop 0
 v_cndmask_b32 v143, v143, v22, vcc
 v_cvt_pk_bf16_f32 v128, v128, v129
 v_cvt_pk_bf16_f32 v129, v130, v131
 v_cvt_pk_bf16_f32 v130, v132, v133
 v_cvt_pk_bf16_f32 v131, v134, v135
 ds_write_b128 v21, v[128:131] offset:32768
 v_cvt_pk_bf16_f32 v132, v136, v137
 v_cvt_pk_bf16_f32 v133, v138, v139
 v_cvt_pk_bf16_f32 v134, v140, v141
 v_cvt_pk_bf16_f32 v135, v142, v143
 ds_write_b128 v21, v[132:135] offset:36864
 v_mov_b32 v208, v24
 v_mov_b32 v209, v25
 v_mov_b32 v210, v26
 v_mov_b32 v211, v27
 v_mov_b32 v254, v23
 s_waitcnt lgkmcnt(0)
 s_barrier
 ds_read_b128 v[96:99], v4 offset:0
 ds_read_b128 v[100:103], v4 offset:512
 ds_read_b128 v[104:107], v6 offset:0
 ds_read_b128 v[108:111], v6 offset:512
 ds_read_b128 v[192:195], v8 offset:0
 ds_read_b128 v[196:199], v9 offset:0
 s_waitcnt lgkmcnt(0)
 v_mfma_f32_16x16x32_bf16 v[12:15], v[248:251], v[192:195], 0
 ds_read_b128 v[112:115], v4 offset:4096
 v_mfma_f32_16x16x32_bf16 v[16:19], v[192:195], v[192:195], 0
 ds_read_b128 v[116:119], v4 offset:4608
 v_mfma_f32_32x32x16_bf16 v[128:143], a[0:3], v[96:99], 0
 ds_read_b128 v[120:123], v6 offset:4096
 ds_read_b128 v[124:127], v6 offset:4608
 ds_read_b128 v[200:203], v8 offset:4096
 ds_read_b128 v[204:207], v9 offset:4096
 v_lshlrev_b32 v222, 3, v2
 v_mfma_f32_32x32x16_bf16 v[128:143], a[4:7], v[100:103], v[128:143]
 s_add_u32 m0, s72, 12288
 s_add_u32 s68, s68, s69
 buffer_load_dwordx4 v208, s[8:11], s68 offen offset:0 lds
 v_and_b32 v223, 32, v0
 s_mul_i32 s38, s37, 160
 s_mov_b32 s71, s45
 v_mfma_f32_16x16x32_bf16 v[12:15], v[248:251], v[196:199], v[12:15]
 buffer_load_dwordx4 v[224:227], v223, s[24:27], s44 offen offset:0
 v_mfma_f32_16x16x32_bf16 v[16:19], v[196:199], v[196:199], v[16:19]
 buffer_load_dwordx4 v[228:231], v223, s[24:27], s44 offen offset:16
 v_mfma_f32_32x32x16_bf16 v[128:143], a[8:11], v[104:107], v[128:143]
 buffer_load_dwordx4 v209, s[8:11], s68 offen offset:1024 lds
 s_lshl_b32 s62, s3, 12
 s_add_u32 s62, s62, 81920
 v_add_u32 v24, s62, v3
 v_mfma_f32_32x32x16_bf16 v[128:143], a[12:15], v[108:111], v[128:143]
 buffer_load_dwordx4 v210, s[8:11], s68 offen offset:2048 lds
 v_xor_b32 v25, 0x1000, v24
 s_lshl_b32 s62, s3, 7
 s_add_u32 s62, s62, 114688
 s_waitcnt lgkmcnt(0)
 v_mfma_f32_16x16x32_bf16 v[12:15], v[248:251], v[200:203], v[12:15]
 ds_read_b128 v[96:99], v4 offset:8192
 v_mfma_f32_16x16x32_bf16 v[16:19], v[200:203], v[200:203], v[16:19]
 ds_read_b128 v[100:103], v4 offset:8704
 v_mfma_f32_32x32x16_bf16 v[128:143], a[16:19], v[112:115], v[128:143]
 ds_read_b128 v[104:107], v6 offset:8192
 ds_read_b128 v[108:111], v6 offset:8704
 ds_read_b128 v[192:195], v8 offset:8192
 ds_read_b128 v[196:199], v9 offset:8192
 v_lshl_add_u32 v28, v1, 3, s62
 v_mfma_f32_32x32x16_bf16 v[128:143], a[20:23], v[116:119], v[128:143]
 buffer_load_dwordx4 v211, s[8:11], s68 offen offset:3072 lds
 v_and_b32 v29, 31, v0
 s_lshl_b32 s62, s46, 8
 s_add_u32 s62, s62, 114688
 v_mfma_f32_16x16x32_bf16 v[12:15], v[248:251], v[204:207], v[12:15]
 v_lshl_add_u32 v29, v29, 3, s62
 v_mfma_f32_16x16x32_bf16 v[16:19], v[204:207], v[204:207], v[16:19]
 v_xor_b32 v30, 0x100, v29
 v_mfma_f32_32x32x16_bf16 v[128:143], a[24:27], v[120:123], v[128:143]
 s_add_u32 m0, s72, 16384
 s_add_u32 s68, s68, s69
 buffer_load_dwordx4 v208, s[8:11], s68 offen offset:0 lds
 v_and_b32 v20, 3, v1
 v_lshrrev_b32 v21, 2, v1
 v_cmp_eq_u32 s[42:43], 2, v20
 v_mfma_f32_32x32x16_bf16 v[128:143], a[28:31], v[124:127], v[128:143]
 buffer_load_dwordx4 v209, s[8:11], s68 offen offset:1024 lds
 v_cmp_eq_u32 s[44:45], 3, v20
 v_cmp_eq_u32 s[62:63], v21, v2
 v_cmp_eq_u32 s[58:59], 1, v20
 s_waitcnt lgkmcnt(0)
 v_mfma_f32_16x16x32_bf16 v[12:15], v[248:251], v[192:195], v[12:15]
 ds_read_b128 v[112:115], v4 offset:12288
 v_mfma_f32_16x16x32_bf16 v[16:19], v[192:195], v[192:195], v[16:19]
 ds_read_b128 v[116:119], v4 offset:12800
 v_mfma_f32_32x32x16_bf16 v[128:143], a[32:35], v[96:99], v[128:143]
 ds_read_b128 v[120:123], v6 offset:12288
 ds_read_b128 v[124:127], v6 offset:12800
 ds_read_b128 v[200:203], v8 offset:12288
 ds_read_b128 v[204:207], v9 offset:12288
 buffer_load_dwordx2 v[212:213], v222, s[28:31], s38 offen offset:0
 v_mfma_f32_32x32x16_bf16 v[128:143], a[36:39], v[100:103], v[128:143]
 buffer_load_dwordx4 v210, s[8:11], s68 offen offset:2048 lds
 buffer_load_dwordx2 v[214:215], v222, s[28:31], s38 offen offset:32
 buffer_load_dwordx2 v[216:217], v222, s[28:31], s38 offen offset:64
 buffer_load_dwordx2 v[218:219], v222, s[28:31], s38 offen offset:96
 v_mfma_f32_16x16x32_bf16 v[12:15], v[248:251], v[196:199], v[12:15]
 buffer_load_dwordx2 v[220:221], v222, s[28:31], s38 offen offset:128
 v_mfma_f32_16x16x32_bf16 v[16:19], v[196:199], v[196:199], v[16:19]
 s_mul_i32 s50, s36, 196608
 v_mfma_f32_32x32x16_bf16 v[128:143], a[40:43], v[104:107], v[128:143]
 s_add_u32 m0, s72, 19456
 s_nop 0
 buffer_load_dwordx4 v254, s[8:11], s70 offen lds
 s_add_u32 s50, s50, 5242880
 s_add_u32 s49, s49, s50
 s_mul_i32 s41, s37, 24576
 v_mfma_f32_32x32x16_bf16 v[128:143], a[44:47], v[108:111], v[128:143]
 s_add_u32 s50, s50, s41
 s_lshl_b32 s41, s46, 11
 s_add_u32 s50, s50, s41
 s_lshl_b32 s52, s47, 12
 s_add_u32 s52, s52, s50
 s_waitcnt lgkmcnt(0)
 v_mfma_f32_16x16x32_bf16 v[12:15], v[248:251], v[200:203], v[12:15]
 ds_read_b128 v[96:99], v4 offset:16384
 v_mfma_f32_16x16x32_bf16 v[16:19], v[200:203], v[200:203], v[16:19]
 ds_read_b128 v[100:103], v4 offset:16896
 v_mfma_f32_32x32x16_bf16 v[128:143], a[48:51], v[112:115], v[128:143]
 ds_read_b128 v[104:107], v6 offset:16384
 ds_read_b128 v[108:111], v6 offset:16896
 ds_read_b128 v[192:195], v8 offset:16384
 ds_read_b128 v[196:199], v9 offset:16384
 s_add_u32 s52, s52, 16384
 v_mfma_f32_32x32x16_bf16 v[128:143], a[52:55], v[116:119], v[128:143]
 buffer_load_dwordx4 v[32:35], v3, s[16:19], s48 offen offset:0 sc1
 s_lshl_b32 s41, s3, 12
 s_add_u32 s50, s50, s41
 s_xor_b32 s73, s50, 0x800
 v_mfma_f32_16x16x32_bf16 v[12:15], v[248:251], v[204:207], v[12:15]
 s_lshl_b32 s53, s2, 11
 v_mfma_f32_16x16x32_bf16 v[16:19], v[204:207], v[204:207], v[16:19]
 s_lshl_b32 s41, s3, 7
 v_mfma_f32_32x32x16_bf16 v[128:143], a[56:59], v[120:123], v[128:143]
 buffer_load_dwordx4 v[36:39], v3, s[16:19], s48 offen offset:1024 sc1
 s_add_u32 s53, s53, s41
 s_add_u32 s53, s53, 11599872
 s_lshl_b32 s41, s3, 7
 v_mfma_f32_32x32x16_bf16 v[128:143], a[60:63], v[124:127], v[128:143]
 s_add_u32 s41, s41, 115712
 v_lshl_add_u32 v31, v2, 4, s41
 v_lshl_add_u32 v31, v1, 6, v31
 v_lshrrev_b32 v27, 1, v223
 v_add_u32 v27, s41, v27
 s_waitcnt lgkmcnt(0)
 v_mfma_f32_16x16x32_bf16 v[12:15], v[248:251], v[192:195], v[12:15]
 ds_read_b128 v[112:115], v4 offset:20480
 v_mfma_f32_16x16x32_bf16 v[16:19], v[192:195], v[192:195], v[16:19]
 ds_read_b128 v[116:119], v4 offset:20992
 v_mfma_f32_32x32x16_bf16 v[128:143], a[64:67], v[96:99], v[128:143]
 ds_read_b128 v[120:123], v6 offset:20480
 ds_read_b128 v[124:127], v6 offset:20992
 ds_read_b128 v[200:203], v8 offset:20480
 ds_read_b128 v[204:207], v9 offset:20480
 s_waitcnt vmcnt(14)
 v_mfma_f32_32x32x16_bf16 v[128:143], a[68:71], v[100:103], v[128:143]
 buffer_load_dwordx4 v[40:43], v3, s[16:19], s48 offen offset:2048 sc1
 v_lshlrev_b32 v176, 16, v224
 v_and_b32 v177, 0xffff0000, v224
 v_lshlrev_b32 v178, 16, v225
 v_mfma_f32_16x16x32_bf16 v[12:15], v[248:251], v[196:199], v[12:15]
 v_and_b32 v179, 0xffff0000, v225
 v_mfma_f32_16x16x32_bf16 v[16:19], v[196:199], v[196:199], v[16:19]
 v_lshlrev_b32 v180, 16, v226
 v_mfma_f32_32x32x16_bf16 v[128:143], a[72:75], v[104:107], v[128:143]
 v_and_b32 v181, 0xffff0000, v226
 v_lshlrev_b32 v182, 16, v227
 v_and_b32 v183, 0xffff0000, v227
 v_lshlrev_b32 v184, 16, v228
 v_and_b32 v185, 0xffff0000, v228
 v_mfma_f32_32x32x16_bf16 v[128:143], a[76:79], v[108:111], v[128:143]
 v_lshlrev_b32 v186, 16, v229
 v_and_b32 v187, 0xffff0000, v229
 v_lshlrev_b32 v188, 16, v230
 v_and_b32 v189, 0xffff0000, v230
 v_lshlrev_b32 v190, 16, v231
 s_waitcnt lgkmcnt(0)
 v_mfma_f32_16x16x32_bf16 v[12:15], v[248:251], v[200:203], v[12:15]
 ds_read_b128 v[96:99], v4 offset:24576
 v_mfma_f32_16x16x32_bf16 v[16:19], v[200:203], v[200:203], v[16:19]
 ds_read_b128 v[100:103], v4 offset:25088
 v_mfma_f32_32x32x16_bf16 v[128:143], a[80:83], v[112:115], v[128:143]
 ds_read_b128 v[104:107], v6 offset:24576
 ds_read_b128 v[108:111], v6 offset:25088
 ds_read_b128 v[192:195], v8 offset:24576
 ds_read_b128 v[196:199], v9 offset:24576
 v_and_b32 v191, 0xffff0000, v231
 v_mfma_f32_32x32x16_bf16 v[128:143], a[84:87], v[116:119], v[128:143]
 buffer_load_dwordx4 v[44:47], v3, s[16:19], s48 offen offset:3072 sc1
 buffer_load_dwordx4 v[224:227], v223, s[24:27], s71 offen offset:0
 buffer_load_dwordx4 v[228:231], v223, s[24:27], s71 offen offset:16
 s_cmp_lt_u32 s37, 4
 s_cselect_b32 s38, 0, 3
 s_cselect_b32 s39, -1, 3
 s_cselect_b32 s40, 1, 0
 v_mfma_f32_16x16x32_bf16 v[12:15], v[248:251], v[204:207], v[12:15]
 v_xor_b32 v22, s38, v2
 v_mfma_f32_16x16x32_bf16 v[16:19], v[204:207], v[204:207], v[16:19]
 v_lshlrev_b32 v23, 4, v1
 v_mfma_f32_32x32x16_bf16 v[128:143], a[88:91], v[120:123], v[128:143]
 s_add_u32 s48, s48, 4096
 buffer_load_dwordx4 v[48:51], v3, s[16:19], s48 offen offset:0 sc1
 v_add_u32 v23, s54, v23
 v_lshrrev_b32 v20, 1, v22
 v_lshl_add_u32 v20, v20, 12, v23
 v_mfma_f32_32x32x16_bf16 v[128:143], a[92:95], v[124:127], v[128:143]
 v_and_b32 v26, 1, v22
 v_lshl_add_u32 v20, v26, 3, v20
 v_lshl_add_u32 v22, v22, 2, s39
 v_bfe_u32 v21, v22, 3, 1
 v_lshl_add_u32 v21, v21, 12, v23
 s_waitcnt vmcnt(7)
 s_barrier
 s_waitcnt lgkmcnt(0)
 v_mfma_f32_16x16x32_bf16 v[12:15], v[248:251], v[192:195], v[12:15]
 ds_read_b128 v[112:115], v4 offset:28672
 v_mfma_f32_16x16x32_bf16 v[16:19], v[192:195], v[192:195], v[16:19]
 ds_read_b128 v[116:119], v4 offset:29184
 v_mfma_f32_32x32x16_bf16 v[128:143], a[96:99], v[96:99], v[128:143]
 ds_read_b128 v[120:123], v6 offset:28672
 ds_read_b128 v[124:127], v6 offset:29184
 ds_read_b128 v[200:203], v8 offset:28672
 ds_read_b128 v[204:207], v9 offset:28672
 ds_read_b64_tr_b16 a[160:161], v11 offset:0
 v_and_b32 v22, 7, v22
 v_mfma_f32_32x32x16_bf16 v[128:143], a[100:103], v[100:103], v[128:143]
 buffer_load_dwordx4 v[52:55], v3, s[16:19], s48 offen offset:1024 sc1
 ds_read_b64_tr_b16 a[162:163], v11 offset:512
 v_lshl_add_u32 v21, v22, 1, v21
 ds_read_b64_tr_b16 a[164:165], v11 offset:2048
 v_cmp_gt_u32 vcc, s40, v2
 v_mfma_f32_16x16x32_bf16 v[12:15], v[248:251], v[196:199], v[12:15]
 ds_read_b64_tr_b16 a[166:167], v11 offset:2560
 v_add_u32 v22, s21, v20
 v_mfma_f32_16x16x32_bf16 v[16:19], v[196:199], v[196:199], v[16:19]
 ds_read_b64_tr_b16 a[168:169], v11 offset:40960
 ds_read_b64 v[232:233], v22
 v_mfma_f32_32x32x16_bf16 v[128:143], a[104:107], v[104:107], v[128:143]
 ds_read_b64_tr_b16 a[170:171], v11 offset:41472
 v_add_u32 v23, s21, v21
 ds_read_b64_tr_b16 a[172:173], v11 offset:43008
 v_add_u32 v26, s20, v21
 ds_read_b64_tr_b16 a[174:175], v11 offset:43520
 v_cndmask_b32 v23, v23, v26, vcc
 v_mfma_f32_32x32x16_bf16 v[128:143], a[108:111], v[108:111], v[128:143]
 ds_read_b64_tr_b16 a[176:177], v11 offset:4096
 s_cmp_eq_u32 s37, 4
 s_cselect_b32 s40, 1, 0
 ds_read_b64_tr_b16 a[178:179], v11 offset:4608
 v_cmp_gt_u32 s[38:39], s40, v2
 ds_read_b64_tr_b16 a[180:181], v11 offset:6144
 v_add_u32 v26, 33536, v21
 s_waitcnt lgkmcnt(12)
 v_mfma_f32_16x16x32_bf16 v[12:15], v[248:251], v[200:203], v[12:15]
 ds_read_b128 v[96:99], v4 offset:32768
 v_mfma_f32_16x16x32_bf16 v[16:19], v[200:203], v[200:203], v[16:19]
 ds_read_b128 v[100:103], v4 offset:33280
 v_mfma_f32_32x32x16_bf16 v[128:143], a[112:115], v[112:115], v[128:143]
 ds_read_b128 v[104:107], v6 offset:32768
 ds_read_b128 v[108:111], v6 offset:33280
 ds_read_b128 v[192:195], v8 offset:32768
 ds_read_b128 v[196:199], v9 offset:32768
 ds_read_b64_tr_b16 a[182:183], v11 offset:6656
 s_nop 0
 v_mfma_f32_32x32x16_bf16 v[128:143], a[116:119], v[116:119], v[128:143]
 buffer_load_dwordx4 v[56:59], v3, s[16:19], s48 offen offset:2048 sc1
 ds_read_b64_tr_b16 a[184:185], v11 offset:45056
 v_cndmask_b32 v23, v23, v26, s[38:39]
 ds_read_b64_tr_b16 a[186:187], v11 offset:45568
 ds_read_u16 v242, v23
 v_mfma_f32_16x16x32_bf16 v[12:15], v[248:251], v[204:207], v[12:15]
 ds_read_b64_tr_b16 a[188:189], v11 offset:47104
 v_add_u32 v22, s12, v20
 v_mfma_f32_16x16x32_bf16 v[16:19], v[204:207], v[204:207], v[16:19]
 ds_read_b64_tr_b16 a[190:191], v11 offset:47616
 ds_read_b64 v[234:235], v22
 v_mfma_f32_32x32x16_bf16 v[128:143], a[120:123], v[120:123], v[128:143]
 buffer_load_dwordx4 v[60:63], v3, s[16:19], s48 offen offset:3072 sc1
 ds_read_b64_tr_b16 a[192:193], v11 offset:8192
 v_add_u32 v23, s12, v21
 ds_read_b64_tr_b16 a[194:195], v11 offset:8704
 v_add_u32 v26, s21, v21
 v_mfma_f32_32x32x16_bf16 v[128:143], a[124:127], v[124:127], v[128:143]
 ds_read_b64_tr_b16 a[196:197], v11 offset:10240
 v_cndmask_b32 v23, v23, v26, vcc
 ds_read_b64_tr_b16 a[198:199], v11 offset:10752
 ds_read_u16 v243, v23
 ds_read_b64_tr_b16 a[200:201], v11 offset:49152
 v_add_u32 v22, s13, v20
 s_waitcnt lgkmcnt(13)
 v_mfma_f32_16x16x32_bf16 v[12:15], v[248:251], v[192:195], v[12:15]
 ds_read_b128 v[112:115], v4 offset:36864
 v_mfma_f32_16x16x32_bf16 v[16:19], v[192:195], v[192:195], v[16:19]
 ds_read_b128 v[116:119], v4 offset:37376
 v_mfma_f32_32x32x16_bf16 v[128:143], a[128:131], v[96:99], v[128:143]
 ds_read_b128 v[120:123], v6 offset:36864
 ds_read_b128 v[124:127], v6 offset:37376
 ds_read_b128 v[200:203], v8 offset:36864
 ds_read_b128 v[204:207], v9 offset:36864
 ds_read_b64_tr_b16 a[202:203], v11 offset:49664
 ds_read_b64 v[236:237], v22
 v_mfma_f32_32x32x16_bf16 v[128:143], a[132:135], v[100:103], v[128:143]
 s_add_u32 s48, s48, 4096
 buffer_load_dwordx4 v[64:67], v3, s[16:19], s48 offen offset:0 sc1
 ds_read_b64_tr_b16 a[204:205], v11 offset:51200
 v_add_u32 v23, s13, v21
 ds_read_b64_tr_b16 a[206:207], v11 offset:51712
 v_add_u32 v26, s12, v21
 v_mfma_f32_16x16x32_bf16 v[12:15], v[248:251], v[196:199], v[12:15]
 ds_read_b64_tr_b16 a[208:209], v11 offset:12288
 v_cndmask_b32 v23, v23, v26, vcc
 v_mfma_f32_16x16x32_bf16 v[16:19], v[196:199], v[196:199], v[16:19]
 ds_read_b64_tr_b16 a[210:211], v11 offset:12800
 ds_read_u16 v244, v23
 v_mfma_f32_32x32x16_bf16 v[128:143], a[136:139], v[104:107], v[128:143]
 ds_read_b64_tr_b16 a[212:213], v11 offset:14336
 v_add_u32 v22, s14, v20
 ds_read_b64_tr_b16 a[214:215], v11 offset:14848
 ds_read_b64 v[238:239], v22
 ds_read_b64_tr_b16 a[216:217], v11 offset:53248
 v_add_u32 v23, s14, v21
 v_mfma_f32_32x32x16_bf16 v[128:143], a[140:143], v[108:111], v[128:143]
 ds_read_b64_tr_b16 a[218:219], v11 offset:53760
 v_add_u32 v26, s13, v21
 ds_read_b64_tr_b16 a[220:221], v11 offset:55296
 v_cndmask_b32 v23, v23, v26, vcc
 ds_read_b64_tr_b16 a[222:223], v11 offset:55808
 ds_read_u16 v245, v23
 s_waitcnt lgkmcnt(15)
 v_mfma_f32_16x16x32_bf16 v[12:15], v[248:251], v[200:203], v[12:15]
 ds_read_b128 v[96:99], v5 offset:0
 v_mfma_f32_16x16x32_bf16 v[16:19], v[200:203], v[200:203], v[16:19]
 ds_read_b128 v[100:103], v5 offset:512
 v_mfma_f32_32x32x16_bf16 v[128:143], a[144:147], v[112:115], v[128:143]
 ds_read_b128 v[104:107], v7 offset:0
 ds_read_b128 v[108:111], v7 offset:512
 buffer_load_dwordx4 v[68:71], v3, s[16:19], s48 offen offset:1024 sc1
 ds_read_b64_tr_b16 a[224:225], v11 offset:16384
 v_add_u32 v22, s15, v20
 v_mfma_f32_32x32x16_bf16 v[128:143], a[148:151], v[116:119], v[128:143]
 buffer_load_dwordx4 v[72:75], v3, s[16:19], s48 offen offset:2048 sc1
 ds_read_b64_tr_b16 a[226:227], v11 offset:16896
 ds_read_b64 v[240:241], v22
 ds_read_b64_tr_b16 a[228:229], v11 offset:18432
 v_add_u32 v23, s15, v21
 v_mfma_f32_16x16x32_bf16 v[12:15], v[248:251], v[204:207], v[12:15]
 ds_read_b64_tr_b16 a[230:231], v11 offset:18944
 v_add_u32 v26, s14, v21
 v_mfma_f32_16x16x32_bf16 v[16:19], v[204:207], v[204:207], v[16:19]
 ds_read_b64_tr_b16 a[232:233], v11 offset:57344
 v_cndmask_b32 v23, v23, v26, vcc
 v_mfma_f32_32x32x16_bf16 v[128:143], a[152:155], v[120:123], v[128:143]
 ds_read_b64_tr_b16 a[234:235], v11 offset:57856
 ds_read_u16 v246, v23
 ds_read_b64_tr_b16 a[236:237], v11 offset:59392
 v_lshrrev_b32 v26, 2, v0
 ds_read_b64_tr_b16 a[238:239], v11 offset:59904
 v_lshlrev_b32 v26, 16, v26
 v_mfma_f32_32x32x16_bf16 v[128:143], a[156:159], v[124:127], v[128:143]
 v_and_b32 v23, 3, v0
 v_lshl_add_u32 v26, v23, 7, v26
 s_and_b32 s39, s2, 31
 s_lshl_b32 s39, s39, 11
 s_lshl_b32 s38, s3, 17
 s_waitcnt lgkmcnt(0)
 s_barrier
 v_mfma_f32_32x32x16_bf16 v[144:159], a[0:3], v[96:99], 0
 ds_read_b128 v[112:115], v5 offset:4096
 ds_read_b128 v[116:119], v5 offset:4608
 ds_read_b128 v[120:123], v7 offset:4096
 ds_read_b128 v[124:127], v7 offset:4608
 buffer_load_dwordx4 v[76:79], v3, s[16:19], s48 offen offset:3072 sc1
 v_mfma_f32_32x32x16_bf16 v[144:159], a[4:7], v[100:103], v[144:159]
 s_add_u32 s48, s48, 4096
 buffer_load_dwordx4 v[80:83], v3, s[16:19], s48 offen offset:0 sc1
 s_mov_b32 exec_lo, 0x00030003
 s_mov_b32 exec_hi, 0x00030003
 ds_write_b128 v31, a[240:243]
 s_mov_b64 exec, -1
 ds_read_b128 v[160:163], v27 offset:0
 ds_read_b128 v[164:167], v27 offset:32
 ds_read_b128 v[168:171], v27 offset:64
 v_mfma_f32_32x32x16_bf16 v[144:159], a[8:11], v[104:107], v[144:159]
 ds_read_b128 v[172:175], v27 offset:96
 v_cndmask_b32 v16, v16, v17, s[58:59]
 v_cndmask_b32 v16, v16, v18, s[42:43]
 v_cndmask_b32 v16, v16, v19, s[44:45]
 v_mul_f32 v12, 0x3acccccd, v12
 v_mul_f32 v16, 0x3acccccd, v16
 v_mfma_f32_32x32x16_bf16 v[144:159], a[12:15], v[108:111], v[144:159]
 v_fma_f32 v16, -v12, v12, v16
 v_max_f32 v16, 0, v16
 v_add_f32 v16, 0x3727c5ac, v16
 v_rsq_f32 v13, v16
 s_mov_b64 exec, s[62:63]
 ds_write_b64 v28, v[12:13]
 s_mov_b64 exec, -1
 s_add_u32 s39, s39, s38
 s_waitcnt lgkmcnt(6)
 v_mfma_f32_32x32x16_bf16 v[144:159], a[16:19], v[112:115], v[144:159]
 ds_read_b128 v[96:99], v5 offset:8192
 ds_read_b128 v[100:103], v5 offset:8704
 ds_read_b128 v[104:107], v7 offset:8192
 ds_read_b128 v[108:111], v7 offset:8704
 buffer_load_dwordx4 v[84:87], v3, s[16:19], s48 offen offset:1024 sc1
 v_mfma_f32_32x32x16_bf16 v[144:159], a[20:23], v[116:119], v[144:159]
 buffer_load_dwordx4 v[88:91], v3, s[16:19], s48 offen offset:2048 sc1
 s_add_u32 s39, s39, 11599872
 v_add_u32 v20, s54, v3
 v_add_u32 v21, s55, v3
 s_waitcnt lgkmcnt(4)
 s_barrier
 v_mfma_f32_32x32x16_bf16 v[144:159], a[24:27], v[120:123], v[144:159]
 ds_read_b64 v[12:13], v29
 ds_read_b64 v[14:15], v30
 v_add_u32 v22, s56, v3
 v_add_u32 v23, s57, v3
 v_mfma_f32_32x32x16_bf16 v[144:159], a[28:31], v[124:127], v[144:159]
 s_waitcnt lgkmcnt(0)
 v_fma_f32 v128, -v12, v160, v128
 v_mfma_f32_32x32x16_bf16 v[144:159], a[32:35], v[96:99], v[144:159]
 ds_read_b128 v[112:115], v5 offset:12288
 ds_read_b128 v[116:119], v5 offset:12800
 ds_read_b128 v[120:123], v7 offset:12288
 ds_read_b128 v[124:127], v7 offset:12800
 buffer_load_dwordx4 v[92:95], v3, s[16:19], s48 offen offset:3072 sc1
 v_mfma_f32_32x32x16_bf16 v[144:159], a[36:39], v[100:103], v[144:159]
 s_add_u32 s48, s48, 4096
 buffer_load_dwordx4 a[0:3], v3, s[16:19], s48 offen offset:0 sc1
 v_fma_f32 v129, -v12, v161, v129
 v_fma_f32 v130, -v12, v162, v130
 v_fma_f32 v131, -v12, v163, v131
 v_fma_f32 v132, -v12, v164, v132
 v_mfma_f32_32x32x16_bf16 v[144:159], a[40:43], v[104:107], v[144:159]
 v_fma_f32 v133, -v12, v165, v133
 v_fma_f32 v134, -v12, v166, v134
 v_fma_f32 v135, -v12, v167, v135
 v_fma_f32 v136, -v12, v168, v136
 v_fma_f32 v137, -v12, v169, v137
 v_fma_f32 v138, -v12, v170, v138
 v_mfma_f32_32x32x16_bf16 v[144:159], a[44:47], v[108:111], v[144:159]
 v_fma_f32 v139, -v12, v171, v139
 v_fma_f32 v140, -v12, v172, v140
 v_fma_f32 v141, -v12, v173, v141
 v_fma_f32 v142, -v12, v174, v142
 v_fma_f32 v143, -v12, v175, v143
 v_fma_f32 v128, v13, v128, v176
 s_waitcnt lgkmcnt(0)
 v_mfma_f32_32x32x16_bf16 v[144:159], a[48:51], v[112:115], v[144:159]
 ds_read_b128 v[96:99], v5 offset:16384
 ds_read_b128 v[100:103], v5 offset:16896
 ds_read_b128 v[104:107], v7 offset:16384
 ds_read_b128 v[108:111], v7 offset:16896
 buffer_load_dwordx4 a[4:7], v3, s[16:19], s48 offen offset:1024 sc1
 v_mfma_f32_32x32x16_bf16 v[144:159], a[52:55], v[116:119], v[144:159]
 buffer_load_dwordx4 a[8:11], v3, s[16:19], s48 offen offset:2048 sc1
 v_fma_f32 v129, v13, v129, v177
 v_fma_f32 v130, v13, v130, v178
 v_fma_f32 v131, v13, v131, v179
 v_fma_f32 v132, v13, v132, v180
 v_mfma_f32_32x32x16_bf16 v[144:159], a[56:59], v[120:123], v[144:159]
 v_fma_f32 v133, v13, v133, v181
 v_fma_f32 v134, v13, v134, v182
 v_fma_f32 v135, v13, v135, v183
 v_fma_f32 v136, v13, v136, v184
 v_fma_f32 v137, v13, v137, v185
 v_fma_f32 v138, v13, v138, v186
 v_mfma_f32_32x32x16_bf16 v[144:159], a[60:63], v[124:127], v[144:159]
 v_fma_f32 v139, v13, v139, v187
 v_fma_f32 v140, v13, v140, v188
 v_fma_f32 v141, v13, v141, v189
 v_fma_f32 v142, v13, v142, v190
 v_fma_f32 v143, v13, v143, v191
 v_max_f32 v128, 0, v128
 s_waitcnt lgkmcnt(0)
 v_mfma_f32_32x32x16_bf16 v[144:159], a[64:67], v[96:99], v[144:159]
 ds_read_b128 v[112:115], v5 offset:20480
 ds_read_b128 v[116:119], v5 offset:20992
 ds_read_b128 v[120:123], v7 offset:20480
 ds_read_b128 v[124:127], v7 offset:20992
 buffer_load_dwordx4 a[12:15], v3, s[16:19], s48 offen offset:3072 sc1
 v_mfma_f32_32x32x16_bf16 v[144:159], a[68:71], v[100:103], v[144:159]
 s_add_u32 s48, s48, 4096
 buffer_load_dwordx4 a[16:19], v3, s[16:19], s48 offen offset:0 sc1
 v_max_f32 v129, 0, v129
 v_max_f32 v130, 0, v130
 v_max_f32 v131, 0, v131
 v_max_f32 v132, 0, v132
 v_mfma_f32_32x32x16_bf16 v[144:159], a[72:75], v[104:107], v[144:159]
 v_max_f32 v133, 0, v133
 v_max_f32 v134, 0, v134
 v_max_f32 v135, 0, v135
 v_mul_f32 v128, v128, v128
 v_mul_f32 v129, v129, v129
 v_mul_f32 v130, v130, v130
 v_mfma_f32_32x32x16_bf16 v[144:159], a[76:79], v[108:111], v[144:159]
 v_mul_f32 v131, v131, v131
 v_mul_f32 v132, v132, v132
 v_mul_f32 v133, v133, v133
 v_mul_f32 v134, v134, v134
 v_mul_f32 v135, v135, v135
 v_cvt_pk_bf16_f32 v128, v128, v129
 s_waitcnt lgkmcnt(0)
 v_mfma_f32_32x32x16_bf16 v[144:159], a[80:83], v[112:115], v[144:159]
 ds_read_b128 v[96:99], v5 offset:24576
 ds_read_b128 v[100:103], v5 offset:25088
 ds_read_b128 v[104:107], v7 offset:24576
 ds_read_b128 v[108:111], v7 offset:25088
 buffer_load_dwordx4 a[20:23], v3, s[16:19], s48 offen offset:1024 sc1
 v_mfma_f32_32x32x16_bf16 v[144:159], a[84:87], v[116:119], v[144:159]
 buffer_load_dwordx4 a[24:27], v3, s[16:19], s48 offen offset:2048 sc1
 v_cvt_pk_bf16_f32 v129, v130, v131
 v_cvt_pk_bf16_f32 v130, v132, v133
 v_cvt_pk_bf16_f32 v131, v134, v135
 buffer_store_dwordx4 v[128:131], v10, s[16:19], s50 offen offset:0 sc1
 v_mfma_f32_32x32x16_bf16 v[144:159], a[88:91], v[120:123], v[144:159]
 v_max_f32 v136, 0, v136
 v_max_f32 v137, 0, v137
 v_max_f32 v138, 0, v138
 v_max_f32 v139, 0, v139
 v_max_f32 v140, 0, v140
 v_max_f32 v141, 0, v141
 v_mfma_f32_32x32x16_bf16 v[144:159], a[92:95], v[124:127], v[144:159]
 v_max_f32 v142, 0, v142
 v_max_f32 v143, 0, v143
 v_mul_f32 v136, v136, v136
 v_mul_f32 v137, v137, v137
 v_mul_f32 v138, v138, v138
 v_mul_f32 v139, v139, v139
 s_waitcnt lgkmcnt(0)
 v_mfma_f32_32x32x16_bf16 v[144:159], a[96:99], v[96:99], v[144:159]
 ds_read_b128 v[112:115], v5 offset:28672
 ds_read_b128 v[116:119], v5 offset:29184
 ds_read_b128 v[120:123], v7 offset:28672
 ds_read_b128 v[124:127], v7 offset:29184
 buffer_load_dwordx4 a[28:31], v3, s[16:19], s48 offen offset:3072 sc1
 v_mfma_f32_32x32x16_bf16 v[144:159], a[100:103], v[100:103], v[144:159]
 s_add_u32 s48, s48, 4096
 buffer_load_dwordx4 a[32:35], v3, s[16:19], s48 offen offset:0 sc1
 v_mul_f32 v140, v140, v140
 v_mul_f32 v141, v141, v141
 v_mul_f32 v142, v142, v142
 v_mul_f32 v143, v143, v143
 v_mfma_f32_32x32x16_bf16 v[144:159], a[104:107], v[104:107], v[144:159]
 v_cvt_pk_bf16_f32 v136, v136, v137
 v_cvt_pk_bf16_f32 v137, v138, v139
 v_cvt_pk_bf16_f32 v138, v140, v141
 v_cvt_pk_bf16_f32 v139, v142, v143
 buffer_store_dwordx4 v[136:139], v10, s[16:19], s50 offen offset:512 sc1
 v_mul_f32 v16, v14, v15
 v_mfma_f32_32x32x16_bf16 v[144:159], a[108:111], v[108:111], v[144:159]
 s_nop 0
 v_fma_f32 v128, -v16, v160, v176
 v_fma_f32 v129, -v16, v161, v177
 v_fma_f32 v130, -v16, v162, v178
 v_fma_f32 v131, -v16, v163, v179
 v_fma_f32 v132, -v16, v164, v180
 s_waitcnt lgkmcnt(0)
 v_mfma_f32_32x32x16_bf16 v[144:159], a[112:115], v[112:115], v[144:159]
 ds_read_b128 v[96:99], v5 offset:32768
 ds_read_b128 v[100:103], v5 offset:33280
 ds_read_b128 v[104:107], v7 offset:32768
 ds_read_b128 v[108:111], v7 offset:33280
 buffer_load_dwordx4 a[36:39], v3, s[16:19], s48 offen offset:1024 sc1
 v_mfma_f32_32x32x16_bf16 v[144:159], a[116:119], v[116:119], v[144:159]
 buffer_load_dwordx4 a[40:43], v3, s[16:19], s48 offen offset:2048 sc1
 v_fma_f32 v133, -v16, v165, v181
 v_fma_f32 v134, -v16, v166, v182
 v_fma_f32 v135, -v16, v167, v183
 v_fma_f32 v136, -v16, v168, v184
 v_mfma_f32_32x32x16_bf16 v[144:159], a[120:123], v[120:123], v[144:159]
 v_fma_f32 v137, -v16, v169, v185
 v_fma_f32 v138, -v16, v170, v186
 v_fma_f32 v139, -v16, v171, v187
 v_fma_f32 v140, -v16, v172, v188
 v_fma_f32 v141, -v16, v173, v189
 v_fma_f32 v142, -v16, v174, v190
 v_mfma_f32_32x32x16_bf16 v[144:159], a[124:127], v[124:127], v[144:159]
 v_fma_f32 v143, -v16, v175, v191
 s_waitcnt lgkmcnt(0)
 v_mfma_f32_32x32x16_bf16 v[144:159], a[128:131], v[96:99], v[144:159]
 ds_read_b128 v[112:115], v5 offset:36864
 ds_read_b128 v[116:119], v5 offset:37376
 ds_read_b128 v[120:123], v7 offset:36864
 ds_read_b128 v[124:127], v7 offset:37376
 buffer_load_dwordx4 a[44:47], v3, s[16:19], s48 offen offset:3072 sc1
 v_mfma_f32_32x32x16_bf16 v[144:159], a[132:135], v[100:103], v[144:159]
 s_add_u32 s48, s48, 4096
 buffer_load_dwordx4 a[48:51], v3, s[16:19], s48 offen offset:0 sc1
 v_mfma_f32_32x32x16_bf16 v[144:159], a[136:139], v[104:107], v[144:159]
 v_mfma_f32_32x32x16_bf16 v[144:159], a[140:143], v[108:111], v[144:159]
 s_waitcnt lgkmcnt(0)
 v_mfma_f32_32x32x16_bf16 v[144:159], a[144:147], v[112:115], v[144:159]
 ds_read_b128 v[96:99], v5 offset:0
 ds_read_b128 v[100:103], v5 offset:512
 ds_read_b128 v[104:107], v5 offset:4096
 ds_read_b128 v[108:111], v5 offset:4608
 buffer_load_dwordx4 a[52:55], v3, s[16:19], s48 offen offset:1024 sc1
 v_mfma_f32_32x32x16_bf16 v[144:159], a[148:151], v[116:119], v[144:159]
 buffer_load_dwordx4 a[56:59], v3, s[16:19], s48 offen offset:2048 sc1
 v_mfma_f32_32x32x16_bf16 v[144:159], a[152:155], v[120:123], v[144:159]
 v_mfma_f32_32x32x16_bf16 v[144:159], a[156:159], v[124:127], v[144:159]
 s_waitcnt lgkmcnt(0)
 v_mfma_f32_16x16x32_bf16 a[248:251], a[160:163], a[244:247], 0
 ds_read_b128 v[112:115], v5 offset:8192
 ds_read_b128 v[116:119], v5 offset:8704
 v_mfma_f32_16x16x32_bf16 a[248:251], a[164:167], a[244:247], a[248:251]
 ds_read_b128 v[120:123], v5 offset:12288
 ds_read_b128 v[124:127], v5 offset:12800
 v_mfma_f32_16x16x32_bf16 a[248:251], a[168:171], a[244:247], a[248:251]
 buffer_load_dwordx4 a[60:63], v3, s[16:19], s48 offen offset:3072 sc1
 v_mfma_f32_16x16x32_bf16 a[248:251], a[172:175], a[244:247], a[248:251]
 s_add_u32 s48, s48, 4096
 buffer_load_dwordx4 a[64:67], v3, s[16:19], s48 offen offset:0 sc1
 v_mfma_f32_16x16x32_bf16 a[248:251], a[176:179], a[244:247], a[248:251]
 buffer_load_dwordx4 a[68:71], v3, s[16:19], s48 offen offset:1024 sc1
 v_mfma_f32_32x32x16_bf16 v[176:191], a[160:163], v[96:99], 0
 s_nop 0
 s_nop 0
 s_nop 0
 s_nop 0
 s_nop 0
 s_nop 0
 v_mfma_f32_32x32x16_bf16 v[176:191], a[164:167], v[100:103], v[176:191]
 s_nop 0
 s_nop 0
 v_fma_f32 v144, v15, v144, v128
 v_fma_f32 v145, v15, v145, v129
 v_fma_f32 v146, v15, v146, v130
 v_fma_f32 v147, v15, v147, v131
 v_mfma_f32_32x32x16_bf16 v[176:191], a[168:171], v[104:107], v[176:191]
 v_fma_f32 v148, v15, v148, v132
 v_fma_f32 v149, v15, v149, v133
 v_fma_f32 v150, v15, v150, v134
 v_fma_f32 v151, v15, v151, v135
 v_fma_f32 v152, v15, v152, v136
 v_fma_f32 v153, v15, v153, v137
 v_mfma_f32_32x32x16_bf16 v[176:191], a[172:175], v[108:111], v[176:191]
 v_fma_f32 v154, v15, v154, v138
 v_fma_f32 v155, v15, v155, v139
 v_fma_f32 v156, v15, v156, v140
 v_fma_f32 v157, v15, v157, v141
 v_fma_f32 v158, v15, v158, v142
 v_fma_f32 v159, v15, v159, v143
 s_waitcnt lgkmcnt(0)
 v_mfma_f32_16x16x32_bf16 a[248:251], a[180:183], a[244:247], a[248:251]
 ds_read_b128 v[96:99], v5 offset:16384
 ds_read_b128 v[100:103], v5 offset:16896
 v_mfma_f32_16x16x32_bf16 a[248:251], a[184:187], a[244:247], a[248:251]
 ds_read_b128 v[104:107], v5 offset:20480
 ds_read_b128 v[108:111], v5 offset:20992
 v_mfma_f32_16x16x32_bf16 a[248:251], a[188:191], a[244:247], a[248:251]
 buffer_load_dwordx4 a[72:75], v3, s[16:19], s48 offen offset:2048 sc1
 v_mfma_f32_16x16x32_bf16 a[248:251], a[192:195], a[244:247], a[248:251]
 buffer_load_dwordx4 a[76:79], v3, s[16:19], s48 offen offset:3072 sc1
 v_mfma_f32_16x16x32_bf16 a[248:251], a[196:199], a[244:247], a[248:251]
 s_add_u32 s48, s48, 4096
 buffer_load_dwordx4 a[80:83], v3, s[16:19], s48 offen offset:0 sc1
 v_mfma_f32_32x32x16_bf16 v[176:191], a[176:179], v[112:115], v[176:191]
 v_max_f32 v144, 0, v144
 v_max_f32 v145, 0, v145
 v_max_f32 v146, 0, v146
 v_max_f32 v147, 0, v147
 v_max_f32 v148, 0, v148
 v_max_f32 v149, 0, v149
 v_mfma_f32_32x32x16_bf16 v[176:191], a[180:183], v[116:119], v[176:191]
 v_max_f32 v150, 0, v150
 v_max_f32 v151, 0, v151
 v_mul_f32 v144, v144, v144
 v_mul_f32 v145, v145, v145
 v_mul_f32 v146, v146, v146
 v_mul_f32 v147, v147, v147
 v_mfma_f32_32x32x16_bf16 v[176:191], a[184:187], v[120:123], v[176:191]
 v_mul_f32 v148, v148, v148
 v_mul_f32 v149, v149, v149
 v_mul_f32 v150, v150, v150
 v_mul_f32 v151, v151, v151
 v_cvt_pk_bf16_f32 v144, v144, v145
 v_cvt_pk_bf16_f32 v145, v146, v147
 v_mfma_f32_32x32x16_bf16 v[176:191], a[188:191], v[124:127], v[176:191]
 v_cvt_pk_bf16_f32 v146, v148, v149
 v_cvt_pk_bf16_f32 v147, v150, v151
 buffer_store_dwordx4 v[144:147], v10, s[16:19], s73 offen offset:0 sc1
 v_max_f32 v152, 0, v152
 v_max_f32 v153, 0, v153
 v_max_f32 v154, 0, v154
 s_waitcnt lgkmcnt(0)
 v_mfma_f32_16x16x32_bf16 a[248:251], a[200:203], a[244:247], a[248:251]
 ds_read_b128 v[112:115], v5 offset:24576
 ds_read_b128 v[116:119], v5 offset:25088
 v_mfma_f32_16x16x32_bf16 a[248:251], a[204:207], a[244:247], a[248:251]
 ds_read_b128 v[120:123], v5 offset:28672
 ds_read_b128 v[124:127], v5 offset:29184
 v_mfma_f32_16x16x32_bf16 a[248:251], a[208:211], a[244:247], a[248:251]
 buffer_load_dwordx4 a[84:87], v3, s[16:19], s48 offen offset:1024 sc1
 v_mfma_f32_16x16x32_bf16 a[248:251], a[212:215], a[244:247], a[248:251]
 buffer_load_dwordx4 a[88:91], v3, s[16:19], s48 offen offset:2048 sc1
 v_mfma_f32_16x16x32_bf16 a[248:251], a[216:219], a[244:247], a[248:251]
 buffer_load_dwordx4 a[92:95], v3, s[16:19], s48 offen offset:3072 sc1
 v_mfma_f32_32x32x16_bf16 v[176:191], a[192:195], v[96:99], v[176:191]
 v_max_f32 v155, 0, v155
 v_max_f32 v156, 0, v156
 v_max_f32 v157, 0, v157
 v_max_f32 v158, 0, v158
 v_max_f32 v159, 0, v159
 v_mul_f32 v152, v152, v152
 v_mfma_f32_32x32x16_bf16 v[176:191], a[196:199], v[100:103], v[176:191]
 v_mul_f32 v153, v153, v153
 v_mul_f32 v154, v154, v154
 v_mul_f32 v155, v155, v155
 v_mul_f32 v156, v156, v156
 v_mul_f32 v157, v157, v157
 v_mul_f32 v158, v158, v158
 v_mfma_f32_32x32x16_bf16 v[176:191], a[200:203], v[104:107], v[176:191]
 v_mul_f32 v159, v159, v159
 v_cvt_pk_bf16_f32 v152, v152, v153
 v_cvt_pk_bf16_f32 v153, v154, v155
 v_cvt_pk_bf16_f32 v154, v156, v157
 v_cvt_pk_bf16_f32 v155, v158, v159
 buffer_store_dwordx4 v[152:155], v10, s[16:19], s73 offen offset:512 sc1
 v_mfma_f32_32x32x16_bf16 v[176:191], a[204:207], v[108:111], v[176:191]
 s_waitcnt vmcnt(40)
 v_lshlrev_b32 v128, 16, v224
 v_and_b32 v129, 0xffff0000, v224
 v_lshlrev_b32 v130, 16, v225
 v_and_b32 v131, 0xffff0000, v225
 v_lshlrev_b32 v132, 16, v226
 s_waitcnt vmcnt(17)
 v_mov_b32 v252, s60
 v_mov_b32 v253, s61
 v_mov_b32 v254, s60
 v_mov_b32 v255, s61
 s_mov_b64 exec, 0xff
 buffer_store_dwordx4 v[252:255], v3, s[16:19], s53 offen offset:0 sc1
 s_mov_b64 exec, -1
 s_waitcnt lgkmcnt(0)
 v_mfma_f32_16x16x32_bf16 a[248:251], a[220:223], a[244:247], a[248:251]
 ds_read_b128 v[96:99], v5 offset:32768
 ds_read_b128 v[100:103], v5 offset:33280
 v_mfma_f32_16x16x32_bf16 a[248:251], a[224:227], a[244:247], a[248:251]
 ds_read_b128 v[104:107], v5 offset:36864
 ds_read_b128 v[108:111], v5 offset:37376
 v_mfma_f32_16x16x32_bf16 a[248:251], a[228:231], a[244:247], a[248:251]
 s_add_u32 s48, s48, 4096
 buffer_load_dwordx4 a[96:99], v3, s[16:19], s48 offen offset:0 sc1
 v_mfma_f32_16x16x32_bf16 a[248:251], a[232:235], a[244:247], a[248:251]
 buffer_load_dwordx4 a[100:103], v3, s[16:19], s48 offen offset:1024 sc1
 v_mfma_f32_16x16x32_bf16 a[248:251], a[236:239], a[244:247], a[248:251]
 buffer_load_dwordx4 a[104:107], v3, s[16:19], s48 offen offset:2048 sc1
 v_mfma_f32_32x32x16_bf16 v[176:191], a[208:211], v[112:115], v[176:191]
 v_and_b32 v133, 0xffff0000, v226
 v_lshlrev_b32 v134, 16, v227
 v_and_b32 v135, 0xffff0000, v227
 v_lshlrev_b32 v136, 16, v228
 v_and_b32 v137, 0xffff0000, v228
 v_lshlrev_b32 v138, 16, v229
 v_mfma_f32_32x32x16_bf16 v[176:191], a[212:215], v[116:119], v[176:191]
 v_and_b32 v139, 0xffff0000, v229
 v_lshlrev_b32 v140, 16, v230
 v_and_b32 v141, 0xffff0000, v230
 v_lshlrev_b32 v142, 16, v231
 v_and_b32 v143, 0xffff0000, v231
 v_mfma_f32_32x32x16_bf16 v[176:191], a[216:219], v[120:123], v[176:191]
 v_mfma_f32_32x32x16_bf16 v[176:191], a[220:223], v[124:127], v[176:191]
 s_waitcnt lgkmcnt(0)
 v_mfma_f32_32x32x16_bf16 v[176:191], a[224:227], v[96:99], v[176:191]
 ds_read_b128 v[112:115], v4 offset:0
 ds_read_b128 v[116:119], v4 offset:512
 ds_read_b128 v[120:123], v4 offset:4096
 ds_read_b128 v[124:127], v4 offset:4608
 buffer_load_dwordx4 a[108:111], v3, s[16:19], s48 offen offset:3072 sc1
 v_mfma_f32_32x32x16_bf16 v[176:191], a[228:231], v[100:103], v[176:191]
 s_add_u32 s48, s48, 4096
 buffer_load_dwordx4 a[112:115], v3, s[16:19], s48 offen offset:0 sc1
 s_mov_b32 exec_lo, 0x00030003
 s_mov_b32 exec_hi, 0x00030003
 ds_write_b128 v31, a[248:251]
 s_mov_b64 exec, -1
 ds_read_b128 v[192:195], v27 offset:0
 ds_read_b128 v[196:199], v27 offset:32
 ds_read_b128 v[200:203], v27 offset:64
 v_mfma_f32_32x32x16_bf16 v[176:191], a[232:235], v[104:107], v[176:191]
 ds_read_b128 v[204:207], v27 offset:96
 v_mfma_f32_32x32x16_bf16 v[176:191], a[236:239], v[108:111], v[176:191]
 s_waitcnt lgkmcnt(5)
 v_mfma_f32_32x32x16_bf16 v[160:175], a[160:163], v[112:115], 0
 ds_read_b128 v[96:99], v4 offset:8192
 ds_read_b128 v[100:103], v4 offset:8704
 ds_read_b128 v[104:107], v4 offset:12288
 ds_read_b128 v[108:111], v4 offset:12800
 buffer_load_dwordx4 a[116:119], v3, s[16:19], s48 offen offset:1024 sc1
 v_mfma_f32_32x32x16_bf16 v[160:175], a[164:167], v[116:119], v[160:175]
 buffer_load_dwordx4 a[120:123], v3, s[16:19], s48 offen offset:2048 sc1
 s_waitcnt lgkmcnt(4)
 v_mul_f32 v16, v12, v13
 v_fma_f32 v128, -v16, v192, v128
 v_fma_f32 v129, -v16, v193, v129
 v_mfma_f32_32x32x16_bf16 v[160:175], a[168:171], v[120:123], v[160:175]
 v_fma_f32 v130, -v16, v194, v130
 v_fma_f32 v131, -v16, v195, v131
 v_fma_f32 v132, -v16, v196, v132
 v_fma_f32 v133, -v16, v197, v133
 v_fma_f32 v134, -v16, v198, v134
 v_fma_f32 v135, -v16, v199, v135
 v_mfma_f32_32x32x16_bf16 v[160:175], a[172:175], v[124:127], v[160:175]
 v_fma_f32 v176, -v14, v192, v176
 v_fma_f32 v177, -v14, v193, v177
 v_fma_f32 v178, -v14, v194, v178
 v_fma_f32 v179, -v14, v195, v179
 ds_write_b128 v24, v[176:179] offset:0
 v_fma_f32 v180, -v14, v196, v180
 s_waitcnt lgkmcnt(1)
 v_mfma_f32_32x32x16_bf16 v[160:175], a[176:179], v[96:99], v[160:175]
 ds_read_b128 v[112:115], v4 offset:16384
 ds_read_b128 v[116:119], v4 offset:16896
 ds_read_b128 v[120:123], v4 offset:20480
 ds_read_b128 v[124:127], v4 offset:20992
 buffer_load_dwordx4 a[124:127], v3, s[16:19], s48 offen offset:3072 sc1
 v_mfma_f32_32x32x16_bf16 v[160:175], a[180:183], v[100:103], v[160:175]
 s_add_u32 s48, s48, 4096
 buffer_load_dwordx4 a[128:131], v3, s[16:19], s48 offen offset:0 sc1
 v_fma_f32 v181, -v14, v197, v181
 v_fma_f32 v182, -v14, v198, v182
 v_fma_f32 v183, -v14, v199, v183
 ds_write_b128 v24, v[180:183] offset:1024
 v_mfma_f32_32x32x16_bf16 v[160:175], a[184:187], v[104:107], v[160:175]
 v_fma_f32 v184, -v14, v200, v184
 v_fma_f32 v185, -v14, v201, v185
 v_fma_f32 v186, -v14, v202, v186
 v_fma_f32 v187, -v14, v203, v187
 ds_write_b128 v24, v[184:187] offset:2048
 v_fma_f32 v188, -v14, v204, v188
 v_mfma_f32_32x32x16_bf16 v[160:175], a[188:191], v[108:111], v[160:175]
 v_fma_f32 v189, -v14, v205, v189
 v_fma_f32 v190, -v14, v206, v190
 v_fma_f32 v191, -v14, v207, v191
 ds_write_b128 v24, v[188:191] offset:3072
 v_fma_f32 v136, -v16, v200, v136
 v_fma_f32 v137, -v16, v201, v137
 s_waitcnt lgkmcnt(3)
 v_mfma_f32_32x32x16_bf16 v[160:175], a[192:195], v[112:115], v[160:175]
 ds_read_b128 v[96:99], v4 offset:24576
 ds_read_b128 v[100:103], v4 offset:25088
 ds_read_b128 v[104:107], v4 offset:28672
 ds_read_b128 v[108:111], v4 offset:29184
 buffer_load_dwordx4 a[132:135], v3, s[16:19], s48 offen offset:1024 sc1
 v_mfma_f32_32x32x16_bf16 v[160:175], a[196:199], v[116:119], v[160:175]
 v_fma_f32 v138, -v16, v202, v138
 v_fma_f32 v139, -v16, v203, v139
 v_fma_f32 v140, -v16, v204, v140
 v_fma_f32 v141, -v16, v205, v141
 v_fma_f32 v142, -v16, v206, v142
 v_fma_f32 v143, -v16, v207, v143
 v_mfma_f32_32x32x16_bf16 v[160:175], a[200:203], v[120:123], v[160:175]
 s_waitcnt lgkmcnt(4)
 s_barrier
 ds_read_b128 v[176:179], v25 offset:0
 ds_read_b128 v[180:183], v25 offset:1024
 ds_read_b128 v[184:187], v25 offset:2048
 ds_read_b128 v[188:191], v25 offset:3072
 v_mfma_f32_32x32x16_bf16 v[160:175], a[204:207], v[124:127], v[160:175]
 s_waitcnt lgkmcnt(4)
 v_mfma_f32_32x32x16_bf16 v[160:175], a[208:211], v[96:99], v[160:175]
 ds_read_b128 v[112:115], v4 offset:32768
 ds_read_b128 v[116:119], v4 offset:33280
 ds_read_b128 v[120:123], v4 offset:36864
 ds_read_b128 v[124:127], v4 offset:37376
 v_mfma_f32_32x32x16_bf16 v[160:175], a[212:215], v[100:103], v[160:175]
 s_waitcnt lgkmcnt(4)
 v_fma_f32 v128, v13, v176, v128
 v_fma_f32 v129, v13, v177, v129
 v_fma_f32 v130, v13, v178, v130
 v_fma_f32 v131, v13, v179, v131
 v_mfma_f32_32x32x16_bf16 v[160:175], a[216:219], v[104:107], v[160:175]
 v_fma_f32 v132, v13, v180, v132
 v_fma_f32 v133, v13, v181, v133
 v_fma_f32 v134, v13, v182, v134
 v_fma_f32 v135, v13, v183, v135
 v_fma_f32 v136, v13, v184, v136
 v_fma_f32 v137, v13, v185, v137
 v_mfma_f32_32x32x16_bf16 v[160:175], a[220:223], v[108:111], v[160:175]
 v_fma_f32 v138, v13, v186, v138
 v_fma_f32 v139, v13, v187, v139
 v_fma_f32 v140, v13, v188, v140
 v_fma_f32 v141, v13, v189, v141
 v_fma_f32 v142, v13, v190, v142
 v_fma_f32 v143, v13, v191, v143
 s_waitcnt lgkmcnt(0)
 v_mfma_f32_32x32x16_bf16 v[160:175], a[224:227], v[112:115], v[160:175]
 v_mfma_f32_32x32x16_bf16 v[160:175], a[228:231], v[116:119], v[160:175]
 v_mfma_f32_32x32x16_bf16 v[160:175], a[232:235], v[120:123], v[160:175]
 v_mfma_f32_32x32x16_bf16 v[160:175], a[236:239], v[124:127], v[160:175]
 s_mov_b64 exec, 0xff
 buffer_load_dwordx2 v[6:7], v26, s[16:19], s39 offen offset:0 sc1
 s_mov_b64 exec, -1
 s_nop 11
 v_fma_f32 v160, v13, v160, v128
 v_fma_f32 v161, v13, v161, v129
 v_fma_f32 v162, v13, v162, v130
 v_fma_f32 v163, v13, v163, v131
 v_fma_f32 v164, v13, v164, v132
 v_fma_f32 v165, v13, v165, v133
 v_fma_f32 v166, v13, v166, v134
 v_fma_f32 v167, v13, v167, v135
 v_fma_f32 v168, v13, v168, v136
 v_fma_f32 v169, v13, v169, v137
 v_fma_f32 v170, v13, v170, v138
 v_fma_f32 v171, v13, v171, v139
 v_fma_f32 v172, v13, v172, v140
 v_fma_f32 v173, v13, v173, v141
 v_fma_f32 v174, v13, v174, v142
 v_fma_f32 v175, v13, v175, v143
 v_max_f32 v160, 0, v160
 v_max_f32 v161, 0, v161
 v_max_f32 v162, 0, v162
 v_max_f32 v163, 0, v163
 v_max_f32 v164, 0, v164
 v_max_f32 v165, 0, v165
 v_max_f32 v166, 0, v166
 v_max_f32 v167, 0, v167
 v_mul_f32 v160, v160, v160
 v_mul_f32 v161, v161, v161
 v_mul_f32 v162, v162, v162
 v_mul_f32 v163, v163, v163
 v_mul_f32 v164, v164, v164
 v_mul_f32 v165, v165, v165
 v_mul_f32 v166, v166, v166
 v_mul_f32 v167, v167, v167
 v_cvt_pk_bf16_f32 v160, v160, v161
 v_cvt_pk_bf16_f32 v161, v162, v163
 v_cvt_pk_bf16_f32 v162, v164, v165
 v_cvt_pk_bf16_f32 v163, v166, v167
 buffer_store_dwordx4 v[160:163], v10, s[16:19], s52 offen offset:0 sc1
 v_max_f32 v168, 0, v168
 v_max_f32 v169, 0, v169
 v_max_f32 v170, 0, v170
 v_max_f32 v171, 0, v171
 v_max_f32 v172, 0, v172
 v_max_f32 v173, 0, v173
 v_max_f32 v174, 0, v174
 v_max_f32 v175, 0, v175
 v_mul_f32 v168, v168, v168
 v_mul_f32 v169, v169, v169
 v_mul_f32 v170, v170, v170
 v_mul_f32 v171, v171, v171
 v_mul_f32 v172, v172, v172
 v_mul_f32 v173, v173, v173
 v_mul_f32 v174, v174, v174
 v_mul_f32 v175, v175, v175
 v_cvt_pk_bf16_f32 v168, v168, v169
 v_cvt_pk_bf16_f32 v169, v170, v171
 v_cvt_pk_bf16_f32 v170, v172, v173
 v_cvt_pk_bf16_f32 v171, v174, v175
 buffer_store_dwordx4 v[168:171], v10, s[16:19], s52 offen offset:512 sc1
 s_waitcnt vmcnt(14)
 v_mov_b32 v252, s60
 v_mov_b32 v253, s61
 v_mov_b32 v254, s60
 v_mov_b32 v255, s61
 s_mov_b64 exec, 0xff
 buffer_store_dwordx4 v[252:255], v3, s[16:19], s53 offen offset:512 sc1
 s_mov_b64 exec, -1
 s_waitcnt vmcnt(3)
 s_mov_b64 exec, 0xff
 s_mov_b32 s38, 0
FZ_POLLA:
 v_cmp_ne_u64 vcc, s[60:61], v[6:7]
 s_add_u32 s38, s38, 1
 s_cmp_eq_u64 vcc, 0
 s_cbranch_scc1 FZ_POLLAOK
 s_cmp_gt_u32 s38, 200000
 s_cbranch_scc1 FZ_POLLAOK
 buffer_load_dwordx2 v[6:7], v26, s[16:19], s39 offen offset:0 sc1
 s_waitcnt vmcnt(0)
 s_branch FZ_POLLA

FZ_POLLAOK:
 s_mov_b64 exec, -1
 s_xor_b32 s40, s47, 0
 s_lshl_b32 s40, s40, 12
 s_add_u32 s40, s40, s49
 buffer_load_dwordx4 a[176:179], v20, s[16:19], s40 offen sc1
 buffer_load_dwordx4 a[180:183], v21, s[16:19], s40 offen sc1
 s_xor_b32 s40, s47, 1
 s_lshl_b32 s40, s40, 12
 s_add_u32 s40, s40, s49
 buffer_load_dwordx4 a[184:187], v22, s[16:19], s40 offen sc1
 buffer_load_dwordx4 a[188:191], v23, s[16:19], s40 offen sc1
 s_xor_b32 s40, s47, 2
 s_lshl_b32 s40, s40, 12
 s_add_u32 s40, s40, s49
 buffer_load_dwordx4 a[192:195], v20, s[16:19], s40 offen sc1
 buffer_load_dwordx4 a[196:199], v21, s[16:19], s40 offen sc1
 s_xor_b32 s40, s47, 3
 s_lshl_b32 s40, s40, 12
 s_add_u32 s40, s40, s49
 buffer_load_dwordx4 a[200:203], v22, s[16:19], s40 offen sc1
 buffer_load_dwordx4 a[204:207], v23, s[16:19], s40 offen sc1
 s_cmp_lt_u32 s37, 4
 s_cselect_b64 vcc, -1, 0
 v_lshlrev_b32 v112, 16, v242
 v_lshlrev_b32 v24, 16, v232
 v_lshlrev_b32 v25, 16, v233
 v_and_b32 v114, 0xffff0000, v232
 v_cndmask_b32 v113, v25, v24, vcc
 v_cndmask_b32 v115, v24, v25, vcc

 v_lshlrev_b32 v116, 16, v243
 v_lshlrev_b32 v24, 16, v234
 v_lshlrev_b32 v25, 16, v235
 v_and_b32 v118, 0xffff0000, v234
 v_cndmask_b32 v117, v25, v24, vcc
 v_cndmask_b32 v119, v24, v25, vcc

 v_lshlrev_b32 v120, 16, v244
 v_lshlrev_b32 v24, 16, v236
 v_lshlrev_b32 v25, 16, v237
 v_and_b32 v122, 0xffff0000, v236
 v_cndmask_b32 v121, v25, v24, vcc
 v_cndmask_b32 v123, v24, v25, vcc

 v_lshlrev_b32 v124, 16, v245
 v_lshlrev_b32 v24, 16, v238
 v_lshlrev_b32 v25, 16, v239
 v_and_b32 v126, 0xffff0000, v238
 v_cndmask_b32 v125, v25, v24, vcc
 v_cndmask_b32 v127, v24, v25, vcc

 v_lshlrev_b32 v128, 16, v246
 v_lshlrev_b32 v24, 16, v240
 v_lshlrev_b32 v25, 16, v241
 v_and_b32 v130, 0xffff0000, v240
 v_cndmask_b32 v129, v25, v24, vcc
 v_cndmask_b32 v131, v24, v25, vcc

 v_lshlrev_b32 v24, 16, v212
 v_and_b32 v25, 0xffff0000, v212
 v_pk_add_f32 v[112:113], v[112:113], v[24:25]
 v_lshlrev_b32 v24, 16, v213
 v_and_b32 v25, 0xffff0000, v213
 v_pk_add_f32 v[114:115], v[114:115], v[24:25]
 v_lshlrev_b32 v24, 16, v214
 v_and_b32 v25, 0xffff0000, v214
 v_pk_add_f32 v[116:117], v[116:117], v[24:25]
 v_lshlrev_b32 v24, 16, v215
 v_and_b32 v25, 0xffff0000, v215
 v_pk_add_f32 v[118:119], v[118:119], v[24:25]
 v_lshlrev_b32 v24, 16, v216
 v_and_b32 v25, 0xffff0000, v216
 v_pk_add_f32 v[120:121], v[120:121], v[24:25]
 v_lshlrev_b32 v24, 16, v217
 v_and_b32 v25, 0xffff0000, v217
 v_pk_add_f32 v[122:123], v[122:123], v[24:25]
 v_lshlrev_b32 v24, 16, v218
 v_and_b32 v25, 0xffff0000, v218
 v_pk_add_f32 v[124:125], v[124:125], v[24:25]
 v_lshlrev_b32 v24, 16, v219
 v_and_b32 v25, 0xffff0000, v219
 v_pk_add_f32 v[126:127], v[126:127], v[24:25]
 v_lshlrev_b32 v24, 16, v220
 v_and_b32 v25, 0xffff0000, v220
 v_pk_add_f32 v[128:129], v[128:129], v[24:25]
 v_lshlrev_b32 v24, 16, v221
 v_and_b32 v25, 0xffff0000, v221
 v_pk_add_f32 v[130:131], v[130:131], v[24:25]
 s_xor_b32 s40, s47, 6
 s_lshl_b32 s40, s40, 12
 s_add_u32 s40, s40, s49
 buffer_load_dwordx4 a[208:211], v20, s[16:19], s40 offen sc1
 buffer_load_dwordx4 a[212:215], v21, s[16:19], s40 offen sc1
 s_xor_b32 s40, s47, 7
 s_lshl_b32 s40, s40, 12
 s_add_u32 s40, s40, s49
 buffer_load_dwordx4 a[216:219], v22, s[16:19], s40 offen sc1
 buffer_load_dwordx4 a[220:223], v23, s[16:19], s40 offen sc1
 s_waitcnt vmcnt(13)
 v_mov_b32 v252, s60
 v_mov_b32 v253, s61
 v_mov_b32 v254, s60
 v_mov_b32 v255, s61
 s_mov_b64 exec, 0xff
 buffer_store_dwordx4 v[252:255], v3, s[16:19], s53 offen offset:1024 sc1
 s_mov_b64 exec, -1
 s_mov_b64 exec, 0xff
 buffer_load_dwordx2 v[6:7], v26, s[16:19], s39 offen offset:512 sc1
 s_mov_b64 exec, -1
 s_waitcnt vmcnt(12)
 v_mfma_f32_16x16x32_bf16 v[112:115], v[32:35], a[176:179], v[112:115]
 s_mul_i32 s44, s3, 15360
 v_mfma_f32_16x16x32_bf16 v[116:119], v[36:39], a[176:179], v[116:119]
 s_xor_b32 s40, s47, 8
 s_lshl_b32 s40, s40, 12
 s_add_u32 s40, s40, s49
 buffer_load_dwordx4 a[224:227], v20, s[16:19], s40 offen sc1
 v_mfma_f32_16x16x32_bf16 v[120:123], v[40:43], a[176:179], v[120:123]
 v_add_u32 v12, s44, v3
 v_mfma_f32_16x16x32_bf16 v[124:127], v[44:47], a[176:179], v[124:127]
 s_mul_i32 s44, s55, 15
 v_mfma_f32_16x16x32_bf16 v[128:131], v[48:51], a[176:179], v[128:131]
 s_add_u32 s44, s44, 0
 v_mfma_f32_16x16x32_bf16 v[132:135], v[32:35], a[180:183], 0
 v_add_u32 v13, s44, v3
 v_mfma_f32_16x16x32_bf16 v[136:139], v[36:39], a[180:183], 0
 buffer_load_dwordx4 a[228:231], v21, s[16:19], s40 offen sc1
 v_mfma_f32_16x16x32_bf16 v[140:143], v[40:43], a[180:183], 0
 s_mul_i32 s44, s56, 15
 v_mfma_f32_16x16x32_bf16 v[144:147], v[44:47], a[180:183], 0
 buffer_load_dwordx4 a[136:139], v3, s[16:19], s48 offen offset:2048 sc1
 v_mfma_f32_16x16x32_bf16 v[148:151], v[48:51], a[180:183], 0
 s_add_u32 s44, s44, 5120
 s_waitcnt vmcnt(13)
 v_mfma_f32_16x16x32_bf16 v[152:155], v[52:55], a[184:187], 0
 v_add_u32 v14, s44, v3
 v_mfma_f32_16x16x32_bf16 v[156:159], v[56:59], a[184:187], 0
 s_xor_b32 s40, s47, 9
 s_lshl_b32 s40, s40, 12
 s_add_u32 s40, s40, s49
 buffer_load_dwordx4 a[232:235], v22, s[16:19], s40 offen sc1
 v_mfma_f32_16x16x32_bf16 v[160:163], v[60:63], a[184:187], 0
 s_mul_i32 s44, s57, 15
 v_mfma_f32_16x16x32_bf16 v[164:167], v[64:67], a[184:187], 0
 s_add_u32 s44, s44, 10240
 v_mfma_f32_16x16x32_bf16 v[168:171], v[68:71], a[184:187], 0
 v_add_u32 v15, s44, v3
 v_mfma_f32_16x16x32_bf16 v[172:175], v[52:55], a[188:191], 0
 s_mul_i32 s44, s3, 2560
 v_mfma_f32_16x16x32_bf16 v[176:179], v[56:59], a[188:191], 0
 buffer_load_dwordx4 a[236:239], v23, s[16:19], s40 offen sc1
 v_mfma_f32_16x16x32_bf16 v[180:183], v[60:63], a[188:191], 0
 s_add_u32 s44, s44, 81920
 v_mfma_f32_16x16x32_bf16 v[184:187], v[64:67], a[188:191], 0
 buffer_load_dwordx4 a[140:143], v3, s[16:19], s48 offen offset:3072 sc1
 v_mfma_f32_16x16x32_bf16 v[188:191], v[68:71], a[188:191], 0
 v_mul_u32_u24 v16, 160, v1
 s_waitcnt vmcnt(14)
 v_mfma_f32_16x16x32_bf16 v[112:115], v[72:75], a[192:195], v[112:115]
 v_lshl_add_u32 v16, v2, 3, v16
 v_mfma_f32_16x16x32_bf16 v[116:119], v[76:79], a[192:195], v[116:119]
 s_add_u32 s48, s48, 4096
 buffer_load_dwordx4 a[144:147], v3, s[16:19], s48 offen offset:0 sc1
 v_mfma_f32_16x16x32_bf16 v[120:123], v[80:83], a[192:195], v[120:123]
 v_add_u32 v16, s44, v16
 v_mfma_f32_16x16x32_bf16 v[124:127], v[84:87], a[192:195], v[124:127]
 v_add_u32 v17, s44, v3
 v_mfma_f32_16x16x32_bf16 v[128:131], v[88:91], a[192:195], v[128:131]
 s_lshl_b32 s44, s46, 10
 v_mfma_f32_16x16x32_bf16 v[132:135], v[72:75], a[196:199], v[132:135]
 s_add_u32 s44, s44, s51
 v_mfma_f32_16x16x32_bf16 v[136:139], v[76:79], a[196:199], v[136:139]
 buffer_load_dwordx4 a[148:151], v3, s[16:19], s48 offen offset:1024 sc1
 v_mfma_f32_16x16x32_bf16 v[140:143], v[80:83], a[196:199], v[140:143]
 s_mul_i32 s44, s44, 1280
 v_mfma_f32_16x16x32_bf16 v[144:147], v[84:87], a[196:199], v[144:147]
 buffer_load_dwordx4 a[152:155], v3, s[16:19], s48 offen offset:2048 sc1
 v_mfma_f32_16x16x32_bf16 v[148:151], v[88:91], a[196:199], v[148:151]
 s_mul_i32 s41, s37, 160
 s_waitcnt vmcnt(15)
 v_mfma_f32_16x16x32_bf16 v[152:155], v[92:95], a[200:203], v[152:155]
 s_add_u32 s44, s44, s41
 v_mfma_f32_16x16x32_bf16 v[156:159], a[0:3], a[200:203], v[156:159]
 buffer_load_dwordx4 a[156:159], v3, s[16:19], s48 offen offset:3072 sc1
 v_mfma_f32_16x16x32_bf16 v[160:163], a[4:7], a[200:203], v[160:163]
 v_add_u32 v24, 0, v0
 v_mfma_f32_16x16x32_bf16 v[164:167], a[8:11], a[200:203], v[164:167]
 v_mul_u32_u24 v25, 6554, v24
 v_mfma_f32_16x16x32_bf16 v[168:171], a[12:15], a[200:203], v[168:171]
 v_lshrrev_b32 v25, 16, v25
 v_mfma_f32_16x16x32_bf16 v[172:175], v[92:95], a[204:207], v[172:175]
 v_mul_u32_u24 v28, 10, v25
 v_mfma_f32_16x16x32_bf16 v[176:179], a[0:3], a[204:207], v[176:179]
 s_add_u32 s48, s48, 4096
 buffer_load_dwordx4 a[160:163], v3, s[16:19], s48 offen offset:0 sc1
 v_mfma_f32_16x16x32_bf16 v[180:183], a[4:7], a[204:207], v[180:183]
 v_sub_u32 v28, v24, v28
 v_mfma_f32_16x16x32_bf16 v[184:187], a[8:11], a[204:207], v[184:187]
 buffer_load_dwordx4 a[164:167], v3, s[16:19], s48 offen offset:1024 sc1
 v_mfma_f32_16x16x32_bf16 v[188:191], a[12:15], a[204:207], v[188:191]
 v_mul_u32_u24 v25, 81920, v25
 s_waitcnt vmcnt(12)
 s_mov_b64 exec, 0xff
 s_mov_b32 s38, 0
FZ_POLLA2:
 v_cmp_ne_u64 vcc, s[60:61], v[6:7]
 s_add_u32 s38, s38, 1
 s_cmp_eq_u64 vcc, 0
 s_cbranch_scc1 FZ_POLLA2OK
 s_cmp_gt_u32 s38, 200000
 s_cbranch_scc1 FZ_POLLA2OK
 buffer_load_dwordx2 v[6:7], v26, s[16:19], s39 offen offset:512 sc1
 s_waitcnt vmcnt(0)
 s_branch FZ_POLLA2

FZ_POLLA2OK:
 s_mov_b64 exec, -1
 v_mfma_f32_16x16x32_bf16 v[112:115], a[16:19], a[208:211], v[112:115]
 v_lshl_add_u32 v96, v28, 4, v25
 v_mfma_f32_16x16x32_bf16 v[116:119], a[20:23], a[208:211], v[116:119]
 s_xor_b32 s40, s47, 0
 s_lshl_b32 s40, s40, 12
 s_add_u32 s40, s40, s49
 buffer_load_dwordx4 a[240:243], v22, s[16:19], s40 offen sc1
 v_mfma_f32_16x16x32_bf16 v[120:123], a[24:27], a[208:211], v[120:123]
 v_add_u32 v24, 64, v0
 v_mfma_f32_16x16x32_bf16 v[124:127], a[28:31], a[208:211], v[124:127]
 v_mul_u32_u24 v25, 6554, v24
 v_mfma_f32_16x16x32_bf16 v[128:131], a[32:35], a[208:211], v[128:131]
 v_lshrrev_b32 v25, 16, v25
 v_mfma_f32_16x16x32_bf16 v[132:135], a[16:19], a[212:215], v[132:135]
 v_mul_u32_u24 v28, 10, v25
 v_mfma_f32_16x16x32_bf16 v[136:139], a[20:23], a[212:215], v[136:139]
 buffer_load_dwordx4 a[244:247], v23, s[16:19], s40 offen sc1
 v_mfma_f32_16x16x32_bf16 v[140:143], a[24:27], a[212:215], v[140:143]
 v_sub_u32 v28, v24, v28
 v_mfma_f32_16x16x32_bf16 v[144:147], a[28:31], a[212:215], v[144:147]
 buffer_load_dwordx4 a[168:171], v3, s[16:19], s48 offen offset:2048 sc1
 v_mfma_f32_16x16x32_bf16 v[148:151], a[32:35], a[212:215], v[148:151]
 v_mul_u32_u24 v25, 81920, v25
 v_mfma_f32_16x16x32_bf16 v[152:155], a[36:39], a[216:219], v[152:155]
 v_lshl_add_u32 v97, v28, 4, v25
 v_mfma_f32_16x16x32_bf16 v[156:159], a[40:43], a[216:219], v[156:159]
 s_xor_b32 s40, s47, 1
 s_lshl_b32 s40, s40, 12
 s_add_u32 s40, s40, s49
 buffer_load_dwordx4 a[248:251], v20, s[16:19], s40 offen sc1
 v_mfma_f32_16x16x32_bf16 v[160:163], a[44:47], a[216:219], v[160:163]
 v_add_u32 v24, 128, v0
 v_mfma_f32_16x16x32_bf16 v[164:167], a[48:51], a[216:219], v[164:167]
 v_mul_u32_u24 v25, 6554, v24
 v_mfma_f32_16x16x32_bf16 v[168:171], a[52:55], a[216:219], v[168:171]
 v_lshrrev_b32 v25, 16, v25
 v_mfma_f32_16x16x32_bf16 v[172:175], a[36:39], a[220:223], v[172:175]
 v_mul_u32_u24 v28, 10, v25
 v_mfma_f32_16x16x32_bf16 v[176:179], a[40:43], a[220:223], v[176:179]
 buffer_load_dwordx4 a[252:255], v21, s[16:19], s40 offen sc1
 v_mfma_f32_16x16x32_bf16 v[180:183], a[44:47], a[220:223], v[180:183]
 v_sub_u32 v28, v24, v28
 v_mfma_f32_16x16x32_bf16 v[184:187], a[48:51], a[220:223], v[184:187]
 buffer_load_dwordx4 a[172:175], v3, s[16:19], s48 offen offset:3072 sc1
 v_mfma_f32_16x16x32_bf16 v[188:191], a[52:55], a[220:223], v[188:191]
 v_mul_u32_u24 v25, 81920, v25
 s_waitcnt vmcnt(16)
 v_mfma_f32_16x16x32_bf16 v[112:115], a[56:59], a[224:227], v[112:115]
 v_lshl_add_u32 v98, v28, 4, v25
 v_mfma_f32_16x16x32_bf16 v[116:119], a[60:63], a[224:227], v[116:119]
 s_xor_b32 s40, s47, 2
 s_lshl_b32 s40, s40, 12
 s_add_u32 s40, s40, s49
 buffer_load_dwordx4 a[176:179], v22, s[16:19], s40 offen sc1
 v_mfma_f32_16x16x32_bf16 v[120:123], a[64:67], a[224:227], v[120:123]
 v_mfma_f32_16x16x32_bf16 v[124:127], a[68:71], a[224:227], v[124:127]
 v_mfma_f32_16x16x32_bf16 v[128:131], a[72:75], a[224:227], v[128:131]
 v_mfma_f32_16x16x32_bf16 v[132:135], a[56:59], a[228:231], v[132:135]
 v_mfma_f32_16x16x32_bf16 v[136:139], a[60:63], a[228:231], v[136:139]
 buffer_load_dwordx4 a[180:183], v23, s[16:19], s40 offen sc1
 v_mfma_f32_16x16x32_bf16 v[140:143], a[64:67], a[228:231], v[140:143]
 v_mfma_f32_16x16x32_bf16 v[144:147], a[68:71], a[228:231], v[144:147]
 v_mfma_f32_16x16x32_bf16 v[148:151], a[72:75], a[228:231], v[148:151]
 s_waitcnt vmcnt(15)
 v_mfma_f32_16x16x32_bf16 v[152:155], a[76:79], a[232:235], v[152:155]
 v_mfma_f32_16x16x32_bf16 v[156:159], a[80:83], a[232:235], v[156:159]
 s_xor_b32 s40, s47, 3
 s_lshl_b32 s40, s40, 12
 s_add_u32 s40, s40, s49
 buffer_load_dwordx4 a[184:187], v20, s[16:19], s40 offen sc1
 v_mfma_f32_16x16x32_bf16 v[160:163], a[84:87], a[232:235], v[160:163]
 v_mfma_f32_16x16x32_bf16 v[164:167], a[88:91], a[232:235], v[164:167]
 v_mfma_f32_16x16x32_bf16 v[168:171], a[92:95], a[232:235], v[168:171]
 v_mfma_f32_16x16x32_bf16 v[172:175], a[76:79], a[236:239], v[172:175]
 v_mfma_f32_16x16x32_bf16 v[176:179], a[80:83], a[236:239], v[176:179]
 buffer_load_dwordx4 a[188:191], v21, s[16:19], s40 offen sc1
 v_mfma_f32_16x16x32_bf16 v[180:183], a[84:87], a[236:239], v[180:183]
 v_mfma_f32_16x16x32_bf16 v[184:187], a[88:91], a[236:239], v[184:187]
 v_mfma_f32_16x16x32_bf16 v[188:191], a[92:95], a[236:239], v[188:191]
 s_mov_b64 exec, 0xff
 buffer_load_dwordx2 v[6:7], v26, s[16:19], s39 offen offset:1024 sc1
 s_mov_b64 exec, -1
 s_waitcnt vmcnt(9)
 v_mfma_f32_16x16x32_bf16 v[152:155], v[32:35], a[240:243], v[152:155]
 v_mfma_f32_16x16x32_bf16 v[156:159], v[36:39], a[240:243], v[156:159]
 s_xor_b32 s40, s47, 6
 s_lshl_b32 s40, s40, 12
 s_add_u32 s40, s40, s49
 buffer_load_dwordx4 a[192:195], v22, s[16:19], s40 offen sc1
 v_mfma_f32_16x16x32_bf16 v[160:163], v[40:43], a[240:243], v[160:163]
 v_mfma_f32_16x16x32_bf16 v[164:167], v[44:47], a[240:243], v[164:167]
 v_mfma_f32_16x16x32_bf16 v[168:171], v[48:51], a[240:243], v[168:171]
 v_mfma_f32_16x16x32_bf16 v[172:175], v[32:35], a[244:247], v[172:175]
 v_mfma_f32_16x16x32_bf16 v[176:179], v[36:39], a[244:247], v[176:179]
 buffer_load_dwordx4 a[196:199], v23, s[16:19], s40 offen sc1
 v_mfma_f32_16x16x32_bf16 v[180:183], v[40:43], a[244:247], v[180:183]
 v_mfma_f32_16x16x32_bf16 v[184:187], v[44:47], a[244:247], v[184:187]
 v_mfma_f32_16x16x32_bf16 v[188:191], v[48:51], a[244:247], v[188:191]
 s_waitcnt vmcnt(8)
 v_mfma_f32_16x16x32_bf16 v[112:115], v[52:55], a[248:251], v[112:115]
 v_mfma_f32_16x16x32_bf16 v[116:119], v[56:59], a[248:251], v[116:119]
 s_xor_b32 s40, s47, 7
 s_lshl_b32 s40, s40, 12
 s_add_u32 s40, s40, s49
 buffer_load_dwordx4 a[200:203], v20, s[16:19], s40 offen sc1
 v_mfma_f32_16x16x32_bf16 v[120:123], v[60:63], a[248:251], v[120:123]
 v_mfma_f32_16x16x32_bf16 v[124:127], v[64:67], a[248:251], v[124:127]
 v_mfma_f32_16x16x32_bf16 v[128:131], v[68:71], a[248:251], v[128:131]
 v_mfma_f32_16x16x32_bf16 v[132:135], v[52:55], a[252:255], v[132:135]
 v_mfma_f32_16x16x32_bf16 v[136:139], v[56:59], a[252:255], v[136:139]
 buffer_load_dwordx4 a[204:207], v21, s[16:19], s40 offen sc1
 v_mfma_f32_16x16x32_bf16 v[140:143], v[60:63], a[252:255], v[140:143]
 v_mfma_f32_16x16x32_bf16 v[144:147], v[64:67], a[252:255], v[144:147]
 v_mfma_f32_16x16x32_bf16 v[148:151], v[68:71], a[252:255], v[148:151]
 s_waitcnt vmcnt(7)
 v_mfma_f32_16x16x32_bf16 v[152:155], v[72:75], a[176:179], v[152:155]
 v_mfma_f32_16x16x32_bf16 v[156:159], v[76:79], a[176:179], v[156:159]
 s_xor_b32 s40, s47, 8
 s_lshl_b32 s40, s40, 12
 s_add_u32 s40, s40, s49
 buffer_load_dwordx4 a[208:211], v22, s[16:19], s40 offen sc1
 v_mfma_f32_16x16x32_bf16 v[160:163], v[80:83], a[176:179], v[160:163]
 v_mfma_f32_16x16x32_bf16 v[164:167], v[84:87], a[176:179], v[164:167]
 v_mfma_f32_16x16x32_bf16 v[168:171], v[88:91], a[176:179], v[168:171]
 v_mfma_f32_16x16x32_bf16 v[172:175], v[72:75], a[180:183], v[172:175]
 v_mfma_f32_16x16x32_bf16 v[176:179], v[76:79], a[180:183], v[176:179]
 buffer_load_dwordx4 a[212:215], v23, s[16:19], s40 offen sc1
 v_mfma_f32_16x16x32_bf16 v[180:183], v[80:83], a[180:183], v[180:183]
 v_mfma_f32_16x16x32_bf16 v[184:187], v[84:87], a[180:183], v[184:187]
 v_mfma_f32_16x16x32_bf16 v[188:191], v[88:91], a[180:183], v[188:191]
 s_waitcnt vmcnt(7)
 v_mfma_f32_16x16x32_bf16 v[112:115], v[92:95], a[184:187], v[112:115]
 v_mfma_f32_16x16x32_bf16 v[116:119], a[0:3], a[184:187], v[116:119]
 s_xor_b32 s40, s47, 9
 s_lshl_b32 s40, s40, 12
 s_add_u32 s40, s40, s49
 buffer_load_dwordx4 a[216:219], v20, s[16:19], s40 offen sc1
 v_mfma_f32_16x16x32_bf16 v[120:123], a[4:7], a[184:187], v[120:123]
 v_mfma_f32_16x16x32_bf16 v[124:127], a[8:11], a[184:187], v[124:127]
 v_mfma_f32_16x16x32_bf16 v[128:131], a[12:15], a[184:187], v[128:131]
 v_mfma_f32_16x16x32_bf16 v[132:135], v[92:95], a[188:191], v[132:135]
 v_mfma_f32_16x16x32_bf16 v[136:139], a[0:3], a[188:191], v[136:139]
 buffer_load_dwordx4 a[220:223], v21, s[16:19], s40 offen sc1
 v_mfma_f32_16x16x32_bf16 v[140:143], a[4:7], a[188:191], v[140:143]
 v_mfma_f32_16x16x32_bf16 v[144:147], a[8:11], a[188:191], v[144:147]
 v_mfma_f32_16x16x32_bf16 v[148:151], a[12:15], a[188:191], v[148:151]
 s_waitcnt vmcnt(8)
 s_mov_b64 exec, 0xff
 s_mov_b32 s38, 0
FZ_POLLB:
 v_cmp_ne_u64 vcc, s[60:61], v[6:7]
 s_add_u32 s38, s38, 1
 s_cmp_eq_u64 vcc, 0
 s_cbranch_scc1 FZ_POLLBOK
 s_cmp_gt_u32 s38, 200000
 s_cbranch_scc1 FZ_POLLBOK
 buffer_load_dwordx2 v[6:7], v26, s[16:19], s39 offen offset:1024 sc1
 s_waitcnt vmcnt(0)
 s_branch FZ_POLLB

FZ_POLLBOK:
 s_mov_b64 exec, -1
 s_xor_b32 s40, s47, 4
 s_lshl_b32 s40, s40, 12
 s_add_u32 s40, s40, s49
 buffer_load_dwordx4 a[224:227], v21, s[16:19], s40 offen sc1
 buffer_load_dwordx4 a[228:231], v22, s[16:19], s40 offen sc1
 buffer_load_dwordx4 a[232:235], v23, s[16:19], s40 offen sc1
 buffer_load_dwordx4 a[236:239], v20, s[16:19], s40 offen sc1
 s_waitcnt vmcnt(10)
 v_mfma_f32_16x16x32_bf16 v[152:155], a[16:19], a[192:195], v[152:155]
 v_mfma_f32_16x16x32_bf16 v[156:159], a[20:23], a[192:195], v[156:159]
 s_xor_b32 s40, s47, 5
 s_lshl_b32 s40, s40, 12
 s_add_u32 s40, s40, s49
 buffer_load_dwordx4 a[240:243], v21, s[16:19], s40 offen sc1
 v_mfma_f32_16x16x32_bf16 v[160:163], a[24:27], a[192:195], v[160:163]
 v_mfma_f32_16x16x32_bf16 v[164:167], a[28:31], a[192:195], v[164:167]
 v_mfma_f32_16x16x32_bf16 v[168:171], a[32:35], a[192:195], v[168:171]
 v_mfma_f32_16x16x32_bf16 v[172:175], a[16:19], a[196:199], v[172:175]
 v_mfma_f32_16x16x32_bf16 v[176:179], a[20:23], a[196:199], v[176:179]
 buffer_load_dwordx4 a[244:247], v22, s[16:19], s40 offen sc1
 v_mfma_f32_16x16x32_bf16 v[180:183], a[24:27], a[196:199], v[180:183]
 v_mfma_f32_16x16x32_bf16 v[184:187], a[28:31], a[196:199], v[184:187]
 v_mfma_f32_16x16x32_bf16 v[188:191], a[32:35], a[196:199], v[188:191]
 s_waitcnt vmcnt(10)
 v_mfma_f32_16x16x32_bf16 v[112:115], a[36:39], a[200:203], v[112:115]
 v_mfma_f32_16x16x32_bf16 v[116:119], a[40:43], a[200:203], v[116:119]
 buffer_load_dwordx4 v[32:35], v23, s[16:19], s40 offen sc1
 v_mfma_f32_16x16x32_bf16 v[120:123], a[44:47], a[200:203], v[120:123]
 v_mfma_f32_16x16x32_bf16 v[124:127], a[48:51], a[200:203], v[124:127]
 v_mfma_f32_16x16x32_bf16 v[128:131], a[52:55], a[200:203], v[128:131]
 v_mfma_f32_16x16x32_bf16 v[132:135], a[36:39], a[204:207], v[132:135]
 v_mfma_f32_16x16x32_bf16 v[136:139], a[40:43], a[204:207], v[136:139]
 buffer_load_dwordx4 v[36:39], v20, s[16:19], s40 offen sc1
 v_mfma_f32_16x16x32_bf16 v[140:143], a[44:47], a[204:207], v[140:143]
 v_mfma_f32_16x16x32_bf16 v[144:147], a[48:51], a[204:207], v[144:147]
 v_mfma_f32_16x16x32_bf16 v[148:151], a[52:55], a[204:207], v[148:151]
 s_waitcnt vmcnt(10)
 v_mfma_f32_16x16x32_bf16 v[152:155], a[56:59], a[208:211], v[152:155]
 v_mfma_f32_16x16x32_bf16 v[156:159], a[60:63], a[208:211], v[156:159]
 s_xor_b32 s40, s47, 10
 s_lshl_b32 s40, s40, 12
 s_add_u32 s40, s40, s49
 buffer_load_dwordx4 v[40:43], v21, s[16:19], s40 offen sc1
 v_mfma_f32_16x16x32_bf16 v[160:163], a[64:67], a[208:211], v[160:163]
 v_mfma_f32_16x16x32_bf16 v[164:167], a[68:71], a[208:211], v[164:167]
 v_mfma_f32_16x16x32_bf16 v[168:171], a[72:75], a[208:211], v[168:171]
 v_mfma_f32_16x16x32_bf16 v[172:175], a[56:59], a[212:215], v[172:175]
 v_mfma_f32_16x16x32_bf16 v[176:179], a[60:63], a[212:215], v[176:179]
 buffer_load_dwordx4 v[44:47], v22, s[16:19], s40 offen sc1
 v_mfma_f32_16x16x32_bf16 v[180:183], a[64:67], a[212:215], v[180:183]
 v_mfma_f32_16x16x32_bf16 v[184:187], a[68:71], a[212:215], v[184:187]
 v_mfma_f32_16x16x32_bf16 v[188:191], a[72:75], a[212:215], v[188:191]
 s_waitcnt vmcnt(10)
 v_mfma_f32_16x16x32_bf16 v[112:115], a[76:79], a[216:219], v[112:115]
 v_mfma_f32_16x16x32_bf16 v[116:119], a[80:83], a[216:219], v[116:119]
 buffer_load_dwordx4 v[48:51], v23, s[16:19], s40 offen sc1
 v_mfma_f32_16x16x32_bf16 v[120:123], a[84:87], a[216:219], v[120:123]
 v_mfma_f32_16x16x32_bf16 v[124:127], a[88:91], a[216:219], v[124:127]
 v_mfma_f32_16x16x32_bf16 v[128:131], a[92:95], a[216:219], v[128:131]
 v_mfma_f32_16x16x32_bf16 v[132:135], a[76:79], a[220:223], v[132:135]
 v_mfma_f32_16x16x32_bf16 v[136:139], a[80:83], a[220:223], v[136:139]
 buffer_load_dwordx4 a[248:251], v20, s[16:19], s40 offen sc1
 v_mfma_f32_16x16x32_bf16 v[140:143], a[84:87], a[220:223], v[140:143]
 v_mfma_f32_16x16x32_bf16 v[144:147], a[88:91], a[220:223], v[144:147]
 v_mfma_f32_16x16x32_bf16 v[148:151], a[92:95], a[220:223], v[148:151]
 s_waitcnt vmcnt(8)
 v_mfma_f32_16x16x32_bf16 v[132:135], a[96:99], a[224:227], v[132:135]
 v_mfma_f32_16x16x32_bf16 v[136:139], a[100:103], a[224:227], v[136:139]
 s_xor_b32 s40, s47, 11
 s_lshl_b32 s40, s40, 12
 s_add_u32 s40, s40, s49
 buffer_load_dwordx4 a[252:255], v21, s[16:19], s40 offen sc1
 v_mfma_f32_16x16x32_bf16 v[140:143], a[104:107], a[224:227], v[140:143]
 v_mfma_f32_16x16x32_bf16 v[144:147], a[108:111], a[224:227], v[144:147]
 v_mfma_f32_16x16x32_bf16 v[148:151], a[112:115], a[224:227], v[148:151]
 v_mfma_f32_16x16x32_bf16 v[152:155], a[96:99], a[228:231], v[152:155]
 v_mfma_f32_16x16x32_bf16 v[156:159], a[100:103], a[228:231], v[156:159]
 buffer_load_dwordx4 v[52:55], v22, s[16:19], s40 offen sc1
 v_mfma_f32_16x16x32_bf16 v[160:163], a[104:107], a[228:231], v[160:163]
 v_mfma_f32_16x16x32_bf16 v[164:167], a[108:111], a[228:231], v[164:167]
 v_mfma_f32_16x16x32_bf16 v[168:171], a[112:115], a[228:231], v[168:171]
 v_mfma_f32_16x16x32_bf16 v[172:175], a[96:99], a[232:235], v[172:175]
 v_mfma_f32_16x16x32_bf16 v[176:179], a[100:103], a[232:235], v[176:179]
 buffer_load_dwordx4 v[56:59], v23, s[16:19], s40 offen sc1
 v_mfma_f32_16x16x32_bf16 v[180:183], a[104:107], a[232:235], v[180:183]
 v_mfma_f32_16x16x32_bf16 v[184:187], a[108:111], a[232:235], v[184:187]
 v_mfma_f32_16x16x32_bf16 v[188:191], a[112:115], a[232:235], v[188:191]
 v_mfma_f32_16x16x32_bf16 v[112:115], a[96:99], a[236:239], v[112:115]
 v_mfma_f32_16x16x32_bf16 v[116:119], a[100:103], a[236:239], v[116:119]
 buffer_load_dwordx4 v[60:63], v20, s[16:19], s40 offen sc1
 v_mfma_f32_16x16x32_bf16 v[120:123], a[104:107], a[236:239], v[120:123]
 v_mfma_f32_16x16x32_bf16 v[124:127], a[108:111], a[236:239], v[124:127]
 v_mfma_f32_16x16x32_bf16 v[128:131], a[112:115], a[236:239], v[128:131]
 s_barrier
 s_waitcnt vmcnt(8)
 v_mfma_f32_16x16x32_bf16 v[132:135], a[116:119], a[240:243], v[132:135]
 v_mfma_f32_16x16x32_bf16 v[136:139], a[120:123], a[240:243], v[136:139]
 v_mfma_f32_16x16x32_bf16 v[140:143], a[124:127], a[240:243], v[140:143]
 v_mfma_f32_16x16x32_bf16 v[144:147], a[128:131], a[240:243], v[144:147]
 v_mfma_f32_16x16x32_bf16 v[148:151], a[132:135], a[240:243], v[148:151]
 v_mfma_f32_16x16x32_bf16 v[152:155], a[116:119], a[244:247], v[152:155]
 v_mfma_f32_16x16x32_bf16 v[156:159], a[120:123], a[244:247], v[156:159]
 v_mfma_f32_16x16x32_bf16 v[160:163], a[124:127], a[244:247], v[160:163]
 v_mfma_f32_16x16x32_bf16 v[164:167], a[128:131], a[244:247], v[164:167]
 v_mfma_f32_16x16x32_bf16 v[168:171], a[132:135], a[244:247], v[168:171]
 v_mfma_f32_16x16x32_bf16 v[172:175], a[116:119], v[32:35], v[172:175]
 v_mfma_f32_16x16x32_bf16 v[176:179], a[120:123], v[32:35], v[176:179]
 v_mfma_f32_16x16x32_bf16 v[180:183], a[124:127], v[32:35], v[180:183]
 v_mfma_f32_16x16x32_bf16 v[184:187], a[128:131], v[32:35], v[184:187]
 v_mfma_f32_16x16x32_bf16 v[188:191], a[132:135], v[32:35], v[188:191]
 v_mfma_f32_16x16x32_bf16 v[112:115], a[116:119], v[36:39], v[112:115]
 v_mfma_f32_16x16x32_bf16 v[116:119], a[120:123], v[36:39], v[116:119]
 v_mfma_f32_16x16x32_bf16 v[120:123], a[124:127], v[36:39], v[120:123]
 v_mfma_f32_16x16x32_bf16 v[124:127], a[128:131], v[36:39], v[124:127]
 v_mfma_f32_16x16x32_bf16 v[128:131], a[132:135], v[36:39], v[128:131]
 s_waitcnt vmcnt(3)
 v_mfma_f32_16x16x32_bf16 v[132:135], a[136:139], v[40:43], v[132:135]
 v_mfma_f32_16x16x32_bf16 v[136:139], a[140:143], v[40:43], v[136:139]
 v_mfma_f32_16x16x32_bf16 v[140:143], a[144:147], v[40:43], v[140:143]
 v_mfma_f32_16x16x32_bf16 v[144:147], a[148:151], v[40:43], v[144:147]
 v_mfma_f32_16x16x32_bf16 v[148:151], a[152:155], v[40:43], v[148:151]
 v_mfma_f32_16x16x32_bf16 v[132:135], a[156:159], a[252:255], v[132:135]
 v_mfma_f32_16x16x32_bf16 v[136:139], a[160:163], a[252:255], v[136:139]
 v_mfma_f32_16x16x32_bf16 v[140:143], a[164:167], a[252:255], v[140:143]
 v_mfma_f32_16x16x32_bf16 v[144:147], a[168:171], a[252:255], v[144:147]
 v_mfma_f32_16x16x32_bf16 v[148:151], a[172:175], a[252:255], v[148:151]
 s_waitcnt vmcnt(2)
 v_mfma_f32_16x16x32_bf16 v[152:155], a[136:139], v[44:47], v[152:155]
 v_mfma_f32_16x16x32_bf16 v[156:159], a[140:143], v[44:47], v[156:159]
 v_mfma_f32_16x16x32_bf16 v[160:163], a[144:147], v[44:47], v[160:163]
 v_mfma_f32_16x16x32_bf16 v[164:167], a[148:151], v[44:47], v[164:167]
 v_mfma_f32_16x16x32_bf16 v[168:171], a[152:155], v[44:47], v[168:171]
 ds_write_b128 v13, v[132:135] offset:0
 v_mfma_f32_16x16x32_bf16 v[152:155], a[156:159], v[52:55], v[152:155]
 ds_write_b128 v13, v[136:139] offset:1024
 v_mfma_f32_16x16x32_bf16 v[156:159], a[160:163], v[52:55], v[156:159]
 ds_write_b128 v13, v[140:143] offset:2048
 v_mfma_f32_16x16x32_bf16 v[160:163], a[164:167], v[52:55], v[160:163]
 ds_write_b128 v13, v[144:147] offset:3072
 v_mfma_f32_16x16x32_bf16 v[164:167], a[168:171], v[52:55], v[164:167]
 ds_write_b128 v13, v[148:151] offset:4096
 v_mfma_f32_16x16x32_bf16 v[168:171], a[172:175], v[52:55], v[168:171]
 s_waitcnt vmcnt(1)
 v_mfma_f32_16x16x32_bf16 v[172:175], a[136:139], v[48:51], v[172:175]
 v_mfma_f32_16x16x32_bf16 v[176:179], a[140:143], v[48:51], v[176:179]
 v_mfma_f32_16x16x32_bf16 v[180:183], a[144:147], v[48:51], v[180:183]
 v_mfma_f32_16x16x32_bf16 v[184:187], a[148:151], v[48:51], v[184:187]
 v_mfma_f32_16x16x32_bf16 v[188:191], a[152:155], v[48:51], v[188:191]
 ds_write_b128 v14, v[152:155] offset:0
 v_mfma_f32_16x16x32_bf16 v[172:175], a[156:159], v[56:59], v[172:175]
 ds_write_b128 v14, v[156:159] offset:1024
 v_mfma_f32_16x16x32_bf16 v[176:179], a[160:163], v[56:59], v[176:179]
 ds_write_b128 v14, v[160:163] offset:2048
 v_mfma_f32_16x16x32_bf16 v[180:183], a[164:167], v[56:59], v[180:183]
 ds_write_b128 v14, v[164:167] offset:3072
 v_mfma_f32_16x16x32_bf16 v[184:187], a[168:171], v[56:59], v[184:187]
 ds_write_b128 v14, v[168:171] offset:4096
 v_mfma_f32_16x16x32_bf16 v[188:191], a[172:175], v[56:59], v[188:191]
 s_waitcnt vmcnt(0)
 v_mfma_f32_16x16x32_bf16 v[112:115], a[136:139], a[248:251], v[112:115]
 v_mfma_f32_16x16x32_bf16 v[116:119], a[140:143], a[248:251], v[116:119]
 v_mfma_f32_16x16x32_bf16 v[120:123], a[144:147], a[248:251], v[120:123]
 v_mfma_f32_16x16x32_bf16 v[124:127], a[148:151], a[248:251], v[124:127]
 v_mfma_f32_16x16x32_bf16 v[128:131], a[152:155], a[248:251], v[128:131]
 ds_write_b128 v15, v[172:175] offset:0
 v_mfma_f32_16x16x32_bf16 v[112:115], a[156:159], v[60:63], v[112:115]
 ds_write_b128 v15, v[176:179] offset:1024
 v_mfma_f32_16x16x32_bf16 v[116:119], a[160:163], v[60:63], v[116:119]
 ds_write_b128 v15, v[180:183] offset:2048
 v_mfma_f32_16x16x32_bf16 v[120:123], a[164:167], v[60:63], v[120:123]
 ds_write_b128 v15, v[184:187] offset:3072
 v_mfma_f32_16x16x32_bf16 v[124:127], a[168:171], v[60:63], v[124:127]
 ds_write_b128 v15, v[188:191] offset:4096
 v_mfma_f32_16x16x32_bf16 v[128:131], a[172:175], v[60:63], v[128:131]
 s_waitcnt lgkmcnt(0)
 s_barrier
 ds_read_b128 v[132:135], v12 offset:0
 ds_read_b128 v[152:155], v12 offset:5120
 ds_read_b128 v[172:175], v12 offset:10240
 ds_read_b128 v[136:139], v12 offset:1024
 ds_read_b128 v[156:159], v12 offset:6144
 ds_read_b128 v[176:179], v12 offset:11264
 ds_read_b128 v[140:143], v12 offset:2048
 ds_read_b128 v[160:163], v12 offset:7168
 ds_read_b128 v[180:183], v12 offset:12288
 ds_read_b128 v[144:147], v12 offset:3072
 ds_read_b128 v[164:167], v12 offset:8192
 ds_read_b128 v[184:187], v12 offset:13312
 ds_read_b128 v[148:151], v12 offset:4096
 ds_read_b128 v[168:171], v12 offset:9216
 ds_read_b128 v[188:191], v12 offset:14336
 s_waitcnt lgkmcnt(12)
 v_pk_add_f32 v[112:113], v[112:113], v[132:133]
 v_pk_add_f32 v[152:153], v[152:153], v[172:173]
 v_pk_add_f32 v[114:115], v[114:115], v[134:135]
 v_pk_add_f32 v[154:155], v[154:155], v[174:175]
 v_pk_add_f32 v[112:113], v[112:113], v[152:153]
 v_pk_add_f32 v[114:115], v[114:115], v[154:155]
 v_cvt_pk_bf16_f32 v100, v112, v113
 v_cvt_pk_bf16_f32 v101, v114, v115
 ds_write_b64 v16, v[100:101] offset:0
 s_waitcnt lgkmcnt(10)
 v_pk_add_f32 v[116:117], v[116:117], v[136:137]
 v_pk_add_f32 v[156:157], v[156:157], v[176:177]
 v_pk_add_f32 v[118:119], v[118:119], v[138:139]
 v_pk_add_f32 v[158:159], v[158:159], v[178:179]
 v_pk_add_f32 v[116:117], v[116:117], v[156:157]
 v_pk_add_f32 v[118:119], v[118:119], v[158:159]
 v_cvt_pk_bf16_f32 v102, v116, v117
 v_cvt_pk_bf16_f32 v103, v118, v119
 ds_write_b64 v16, v[102:103] offset:32
 s_waitcnt lgkmcnt(8)
 v_pk_add_f32 v[120:121], v[120:121], v[140:141]
 v_pk_add_f32 v[160:161], v[160:161], v[180:181]
 v_pk_add_f32 v[122:123], v[122:123], v[142:143]
 v_pk_add_f32 v[162:163], v[162:163], v[182:183]
 v_pk_add_f32 v[120:121], v[120:121], v[160:161]
 v_pk_add_f32 v[122:123], v[122:123], v[162:163]
 v_cvt_pk_bf16_f32 v104, v120, v121
 v_cvt_pk_bf16_f32 v105, v122, v123
 ds_write_b64 v16, v[104:105] offset:64
 s_waitcnt lgkmcnt(6)
 v_pk_add_f32 v[124:125], v[124:125], v[144:145]
 v_pk_add_f32 v[164:165], v[164:165], v[184:185]
 v_pk_add_f32 v[126:127], v[126:127], v[146:147]
 v_pk_add_f32 v[166:167], v[166:167], v[186:187]
 v_pk_add_f32 v[124:125], v[124:125], v[164:165]
 v_pk_add_f32 v[126:127], v[126:127], v[166:167]
 v_cvt_pk_bf16_f32 v106, v124, v125
 v_cvt_pk_bf16_f32 v107, v126, v127
 ds_write_b64 v16, v[106:107] offset:96
 s_waitcnt lgkmcnt(4)
 v_pk_add_f32 v[128:129], v[128:129], v[148:149]
 v_pk_add_f32 v[168:169], v[168:169], v[188:189]
 v_pk_add_f32 v[130:131], v[130:131], v[150:151]
 v_pk_add_f32 v[170:171], v[170:171], v[190:191]
 v_pk_add_f32 v[128:129], v[128:129], v[168:169]
 v_pk_add_f32 v[130:131], v[130:131], v[170:171]
 v_cvt_pk_bf16_f32 v108, v128, v129
 v_cvt_pk_bf16_f32 v109, v130, v131
 ds_write_b64 v16, v[108:109] offset:128
 ds_read_b128 v[228:231], v17 offset:0
 ds_read_b128 v[232:235], v17 offset:1024
 ds_read_b128 v[236:239], v17 offset:2048
 s_waitcnt lgkmcnt(2)
 buffer_store_dwordx4 v[228:231], v96, s[32:35], s44 offen
 s_waitcnt lgkmcnt(1)
 buffer_store_dwordx4 v[232:235], v97, s[32:35], s44 offen
 s_waitcnt lgkmcnt(0)
 s_mov_b32 exec_hi, 0
 buffer_store_dwordx4 v[236:239], v98, s[32:35], s44 offen
 s_mov_b32 exec_hi, -1
FZ_END:
 s_endpgm
 .fill 3072, 4, 0xbf800000
.section .rodata,"a"
.p2align 6
.amdhsa_kernel sequential_preLN__spectral_fnet__dense_activation_squared_relu__prompt_kernel
  .amdhsa_next_free_vgpr 512
  .amdhsa_next_free_sgpr 102
  .amdhsa_accum_offset 256
  .amdhsa_group_segment_fixed_size 0
  .amdhsa_kernarg_size 104
  .amdhsa_user_sgpr_count 2
  .amdhsa_user_sgpr_kernarg_segment_ptr 1
  .amdhsa_system_sgpr_workgroup_id_x 1
.end_amdhsa_kernel
```
